```python
import torch

def _softmax(x, axis=-1):
    return torch.softmax(x, dim=axis)
def _gelu(x):
    return torch.nn.functional.gelu(x, approximate="tanh")
def _silu(x):
    return torch.nn.functional.silu(x)
def _sigmoid(x):
    return torch.sigmoid(x)
def _layernorm(x, axis=-1, eps=1e-5):
    m = x.mean(dim=axis, keepdim=True)
    v = x.var(dim=axis, keepdim=True, unbiased=False)
    return (x - m) / torch.sqrt(v + eps)
def _scatter_add(tgt, idx, src, axis=0):
    return tgt.clone().index_add_(axis, idx, src)
def _segment_sum(src, seg, n):
    out = torch.zeros((n,) + src.shape[1:], dtype=src.dtype)
    return out.index_add_(0, seg, src)
def _pad(x, pw):
    flat = tuple(v for pair in reversed(pw) for v in pair)
    return torch.nn.functional.pad(x, flat)

kernel_name = 'gated_mix__ssm_conv_s4__linear_attn_block__prompt'

def setup_inputs():

    _w = (lambda a: (lambda t: t.to(torch.bfloat16) if t.is_floating_point() else t)(torch.as_tensor(a)))
    def _A_setup():
        B, L, D, N = 1, 2048, 1024, 128
        A_re = -(lambda _x: torch.exp(torch.as_tensor(_x)))((lambda *s: torch.randn(*s, dtype=torch.bfloat16) * 3.2)(D, N))
        A_im = torch.pi * (lambda *s: torch.randn(*s, dtype=torch.bfloat16) * 0.05)(D, N)
        B_re = (lambda *s: torch.randn(*s, dtype=torch.bfloat16) * 0.2)(D, N)
        B_im = (lambda *s: torch.randn(*s, dtype=torch.bfloat16) * 0.2)(D, N)
        C_re = (lambda *s: torch.randn(*s, dtype=torch.bfloat16) * 0.2)(D, N)
        C_im = (lambda *s: torch.randn(*s, dtype=torch.bfloat16) * 0.2)(D, N)
        log_dt = (lambda *s: torch.randn(*s, dtype=torch.bfloat16) * 0.05)(D) * 0.5 - 4.0
        Dskip = (lambda *s: torch.randn(*s, dtype=torch.bfloat16) * 0.1)(D)
        return {
            "u": _w((lambda *s: torch.randn(*s, dtype=torch.bfloat16) * 0.05)(B, L, D)),
            "A_re": _w(A_re),
            "A_im": _w(A_im),
            "B_re": _w(B_re),
            "B_im": _w(B_im),
            "C_re": _w(C_re),
            "C_im": _w(C_im),
            "log_dt": _w(log_dt),
            "Dskip": _w(Dskip),
        }
    _A_in = _A_setup()

    def _B_setup():
        B, S, D = 1, 2048, 1024
        return {
            "x": _w((lambda *s: torch.randn(*s, dtype=torch.bfloat16) * 0.05)(B, S, D)),
            "wqkv": _w((lambda *s: torch.randn(*s, dtype=torch.bfloat16) * 0.8)(D, 3 * D)),
            "wo": _w((lambda *s: torch.randn(*s, dtype=torch.bfloat16) * 0.05)(D, D)),
        }
    _B_in = _B_setup()

    return {
        "A_u": _A_in["u"],
        "A_A_re": _A_in["A_re"],
        "A_A_im": _A_in["A_im"],
        "A_B_re": _A_in["B_re"],
        "A_B_im": _A_in["B_im"],
        "A_C_re": _A_in["C_re"],
        "A_C_im": _A_in["C_im"],
        "A_log_dt": _A_in["log_dt"],
        "A_Dskip": _A_in["Dskip"],
        "B_x": _B_in["x"],
        "B_wqkv": _B_in["wqkv"],
        "B_wo": _B_in["wo"],
        "gate_w": _w((lambda *s: torch.randn(*s, dtype=torch.bfloat16) * 0.05)(1024) * 16.0),
    }

def reference(A_u, A_A_re, A_A_im, A_B_re, A_B_im, A_C_re, A_C_im, A_log_dt, A_Dskip, B_x, B_wqkv, B_wo, gate_w):
    def _A_ref(u, A_re, A_im, B_re, B_im, C_re, C_im, log_dt, Dskip):
        Bsz, L, D = u.shape
        dt = torch.exp(log_dt)[:, None]
        A = A_re + 1j * A_im
        Bc = B_re + 1j * B_im
        Cc = C_re + 1j * C_im
        logdA = dt * A
        dB = dt * Bc
        l = (lambda x, dt: x.to(dt))(torch.arange(L), A_re.dtype)
        P = torch.exp(logdA[:, :, None] * l[None, None, :])
        K = torch.einsum("dn,dnl,dn->dl", Cc, P, dB).real
        L2 = 2 * L
        Kp = _pad(K, ((0, 0), (0, L)))
        up = (lambda x, *d: x.permute(*d))(u, 0, 2, 1)
        up = _pad(up, ((0, 0), (0, 0), (0, L)))
        Kf = (lambda x, axes=(-2,-1): torch.fft.rfft2(x.float(), dim=axes))(Kp[:, None, :], axes=(-2, -1))
        Uf = (lambda x, axes=(-2,-1): torch.fft.rfft2(x.float(), dim=axes))(up[:, :, None, :], axes=(-2, -1))
        Yf = Uf * Kf[None, :, :, :]
        y = (lambda x, s, axes=(-2,-1): torch.fft.irfft2(x, s=s, dim=axes).to(torch.bfloat16))(Yf, (1, L2), axes=(-2, -1))[:, :, 0, :L]
        y = (lambda x, *d: x.permute(*d))(y, 0, 2, 1) + u * Dskip[None, None, :]
        return y

    def _B_ref(x, wqkv, wo):
        B, S, D = x.shape
        H = 32; Dh = D // H
        qkv = (lambda x, *d: x.permute(*d))((x @ wqkv).reshape(B, S, 3, H, Dh), 2, 0, 3, 1, 4)
        q, k, v = qkv[0], qkv[1], qkv[2]
        phi = lambda t: torch.where(t > 0, t + 1, torch.exp(t)) + 1e-6
        pq, pk = phi(q), phi(k)
        kv = torch.einsum("bhsd,bhse->bhde", pk, v)
        z = torch.einsum("bhsd->bhd", pk)
        num = torch.einsum("bhqd,bhde->bhqe", pq, kv)
        den = torch.einsum("bhqd,bhd->bhq", pq, z)[..., None] + 1e-6
        o = num / den
        return (lambda x, *d: x.permute(*d))(o, 0, 2, 1, 3).reshape(B, S, D) @ wo

    x = A_u
    g = _sigmoid((x * gate_w).sum(-1, keepdims=True))
    a = _A_ref(x, A_A_re, A_A_im, A_B_re, A_B_im, A_C_re, A_C_im, A_log_dt, A_Dskip)
    b = _B_ref(x, B_wqkv, B_wo)
    return g * a + (1 - g) * b
```

```asm
; @launch kernel=k1_kernel grid=(768,1,1) block=(256,1,1) lds=81920
; @launch kernel=k2_kernel grid=(256,1,1) block=(256,1,1) lds=129024
; @launch kernel=k3_kernel grid=(256,1,1) block=(256,1,1) lds=90112
.amdgcn_target "amdgcn-amd-amdhsa--gfx950"
.text
.globl k1_kernel
.p2align 8
.type k1_kernel,@function
k1_kernel:
    s_load_dwordx2 s[4:5], s[0:1], 0
    s_load_dwordx2 s[6:7], s[0:1], 120
    s_waitcnt lgkmcnt(0)
    s_cmp_lt_u32 s2, 256
    s_cbranch_scc1 k1_kg
    s_sub_u32 s2, s2, 256
    s_cmp_lt_u32 s2, 256
    s_cbranch_scc1 k1_qkv
    s_sub_u32 s2, s2, 256
    s_cmp_lt_u32 s2, 256
    s_cbranch_scc1 k1_tr
    s_endpgm
k1_qkv:
    s_load_dwordx2 s[44:45], s[0:1], 80
    s_waitcnt lgkmcnt(0)
    s_mov_b32 s8, s4
    s_and_b32 s9, s5, 0xffff
    s_mov_b32 s10, 0x400000
    s_mov_b32 s11, 0x00020000
    s_mov_b32 s12, s44
    s_and_b32 s13, s45, 0xffff
    s_mov_b32 s14, 0x600000
    s_mov_b32 s15, 0x00020000
    s_add_u32 s16, s6, 0x2000000
    s_addc_u32 s17, s7, 0
    s_and_b32 s17, s17, 0xffff
    s_mov_b32 s18, 0x400000
    s_mov_b32 s19, 0x00020000
    s_add_u32 s60, s6, 0x2400000
    s_addc_u32 s61, s7, 0
    s_and_b32 s61, s61, 0xffff
    s_mov_b32 s62, 0x400000
    s_mov_b32 s63, 0x00020000
    s_add_u32 s64, s6, 0x2800000
    s_addc_u32 s65, s7, 0
    s_and_b32 s65, s65, 0xffff
    s_mov_b32 s66, 0x40000
    s_mov_b32 s67, 0x00020000
    s_mov_b32 s40, 0x3fb8aa3b
    s_mov_b32 s42, 0x358637bd
    v_and_b32 v1, 63, v0
    v_lshrrev_b32 v2, 6, v0
    s_nop 1
    v_readfirstlane_b32 s20, v2
    s_nop 3
    s_and_b32 s25, s2, 7
    s_lshr_b32 s26, s2, 3
    s_lshr_b32 s21, s25, 1
    s_lshl_b32 s21, s21, 2
    s_lshr_b32 s27, s26, 3
    s_add_u32 s21, s21, s27
    s_and_b32 s22, s25, 1
    s_lshl_b32 s22, s22, 3
    s_and_b32 s27, s26, 7
    s_add_u32 s22, s22, s27
    s_lshr_b32 s23, s20, 1
    s_and_b32 s24, s20, 1
    v_lshrrev_b32 v3, 2, v1
    v_and_b32 v4, 3, v1
    v_lshrrev_b32 v5, 2, v3
    v_xor_b32 v4, v4, v5
    v_lshlrev_b32 v4, 4, v4
    v_lshl_add_u32 v2, v3, 11, v4
    s_lshl_b32 s25, s22, 7
    v_add_u32 v7, 0, v1
    v_mul_u32_u24 v8, 171, v7
    v_lshrrev_b32 v8, 12, v8
    v_mul_u32_u24 v9, 24, v8
    v_sub_u32 v9, v7, v9
    v_lshrrev_b32 v10, 1, v8
    v_and_b32 v10, 1, v10
    v_lshlrev_b32 v10, 2, v10
    v_xor_b32 v9, v9, v10
    v_lshrrev_b32 v10, 3, v9
    v_and_b32 v9, 7, v9
    v_lshlrev_b32 v9, 4, v9
    v_lshl_add_u32 v9, v10, 11, v9
    v_mul_u32_u24 v8, 6144, v8
    v_add3_u32 v4, v8, v9, s25
    v_add_u32 v7, 64, v1
    v_mul_u32_u24 v8, 171, v7
    v_lshrrev_b32 v8, 12, v8
    v_mul_u32_u24 v9, 24, v8
    v_sub_u32 v9, v7, v9
    v_lshrrev_b32 v10, 1, v8
    v_and_b32 v10, 1, v10
    v_lshlrev_b32 v10, 2, v10
    v_xor_b32 v9, v9, v10
    v_lshrrev_b32 v10, 3, v9
    v_and_b32 v9, 7, v9
    v_lshlrev_b32 v9, 4, v9
    v_lshl_add_u32 v9, v10, 11, v9
    v_mul_u32_u24 v8, 6144, v8
    v_add3_u32 v5, v8, v9, s25
    v_add_u32 v7, 128, v1
    v_mul_u32_u24 v8, 171, v7
    v_lshrrev_b32 v8, 12, v8
    v_mul_u32_u24 v9, 24, v8
    v_sub_u32 v9, v7, v9
    v_lshrrev_b32 v10, 1, v8
    v_and_b32 v10, 1, v10
    v_lshlrev_b32 v10, 2, v10
    v_xor_b32 v9, v9, v10
    v_lshrrev_b32 v10, 3, v9
    v_and_b32 v9, 7, v9
    v_lshlrev_b32 v9, 4, v9
    v_lshl_add_u32 v9, v10, 11, v9
    v_mul_u32_u24 v8, 6144, v8
    v_add3_u32 v6, v8, v9, s25
    v_and_b32 v7, 31, v1
    v_lshrrev_b32 v8, 5, v1
    v_lshrrev_b32 v9, 2, v7
    v_and_b32 v9, 3, v9
    s_lshl_b32 s26, s23, 12
    v_add_u32 v10, 0, v8
    v_xor_b32 v10, v10, v9
    v_lshlrev_b32 v10, 4, v10
    v_lshl_add_u32 v10, v7, 6, v10
    v_add_u32 v12, s26, v10
    v_add_u32 v10, 2, v8
    v_xor_b32 v10, v10, v9
    v_lshlrev_b32 v10, 4, v10
    v_lshl_add_u32 v10, v7, 6, v10
    v_add_u32 v13, s26, v10
    v_and_b32 v10, 15, v1
    v_lshrrev_b32 v10, 2, v10
    v_lshl_add_u32 v11, v8, 3, v10
    v_mul_u32_u24 v11, 384, v11
    v_lshrrev_b32 v10, 1, v10
    v_lshlrev_b32 v10, 6, v10
    v_lshrrev_b32 v16, 4, v1
    v_and_b32 v16, 1, v16
    v_lshlrev_b32 v16, 5, v16
    v_and_b32 v17, 3, v1
    v_lshl_add_u32 v16, v17, 3, v16
    s_lshl_b32 s26, s24, 6
    v_add_u32 v16, s26, v16
    v_xor_b32 v16, v16, v10
    v_add_u32 v16, v16, v11
    v_add_u32 v16, 8192, v16
    s_lshl_b32 s27, s21, 18
    s_lshl_b32 s28, s20, 16
    s_add_u32 s27, s27, s28
    s_mul_i32 s28, s20, 8*6144
    s_mov_b32 s29, 0
    s_mov_b32 s30, 0
    v_mov_b32 v64, 0
    v_mov_b32 v65, 0
    v_mov_b32 v66, 0
    v_mov_b32 v67, 0
    v_mov_b32 v68, 0
    v_mov_b32 v69, 0
    v_mov_b32 v70, 0
    v_mov_b32 v71, 0
    v_mov_b32 v72, 0
    v_mov_b32 v73, 0
    v_mov_b32 v74, 0
    v_mov_b32 v75, 0
    v_mov_b32 v76, 0
    v_mov_b32 v77, 0
    v_mov_b32 v78, 0
    v_mov_b32 v79, 0
    v_mov_b32 v80, 0
    v_mov_b32 v81, 0
    v_mov_b32 v82, 0
    v_mov_b32 v83, 0
    v_mov_b32 v84, 0
    v_mov_b32 v85, 0
    v_mov_b32 v86, 0
    v_mov_b32 v87, 0
    v_mov_b32 v88, 0
    v_mov_b32 v89, 0
    v_mov_b32 v90, 0
    v_mov_b32 v91, 0
    v_mov_b32 v92, 0
    v_mov_b32 v93, 0
    v_mov_b32 v94, 0
    v_mov_b32 v95, 0
    v_mov_b32 v96, 0
    v_mov_b32 v97, 0
    v_mov_b32 v98, 0
    v_mov_b32 v99, 0
    v_mov_b32 v100, 0
    v_mov_b32 v101, 0
    v_mov_b32 v102, 0
    v_mov_b32 v103, 0
    v_mov_b32 v104, 0
    v_mov_b32 v105, 0
    v_mov_b32 v106, 0
    v_mov_b32 v107, 0
    v_mov_b32 v108, 0
    v_mov_b32 v109, 0
    v_mov_b32 v110, 0
    v_mov_b32 v111, 0
    v_mov_b32 v112, 0
    v_mov_b32 v113, 0
    v_mov_b32 v114, 0
    v_mov_b32 v115, 0
    v_mov_b32 v116, 0
    v_mov_b32 v117, 0
    v_mov_b32 v118, 0
    v_mov_b32 v119, 0
    v_mov_b32 v120, 0
    v_mov_b32 v121, 0
    v_mov_b32 v122, 0
    v_mov_b32 v123, 0
    v_mov_b32 v124, 0
    v_mov_b32 v125, 0
    v_mov_b32 v126, 0
    v_mov_b32 v127, 0
    v_mov_b32 v128, 0
    v_mov_b32 v129, 0
    v_mov_b32 v130, 0
    v_mov_b32 v131, 0
    v_mov_b32 v132, 0
    v_mov_b32 v133, 0
    v_mov_b32 v134, 0
    v_mov_b32 v135, 0
    v_mov_b32 v136, 0
    v_mov_b32 v137, 0
    v_mov_b32 v138, 0
    v_mov_b32 v139, 0
    v_mov_b32 v140, 0
    v_mov_b32 v141, 0
    v_mov_b32 v142, 0
    v_mov_b32 v143, 0
    v_mov_b32 v144, 0
    v_mov_b32 v145, 0
    v_mov_b32 v146, 0
    v_mov_b32 v147, 0
    v_mov_b32 v148, 0
    v_mov_b32 v149, 0
    v_mov_b32 v150, 0
    v_mov_b32 v151, 0
    v_mov_b32 v152, 0
    v_mov_b32 v153, 0
    v_mov_b32 v154, 0
    v_mov_b32 v155, 0
    v_mov_b32 v156, 0
    v_mov_b32 v157, 0
    v_mov_b32 v158, 0
    v_mov_b32 v159, 0
    s_lshl_b32 s31, s29, 6
    s_add_u32 s31, s31, s27
    s_lshl_b32 s32, s20, 11
    s_add_u32 s32, s32, s30
    s_add_u32 s33, s32, 0
    s_mov_b32 m0, s33
    s_add_u32 s34, s31, 0
    s_nop 0
    buffer_load_dwordx4 v2, s[8:11], s34 offen lds
    s_add_u32 s33, s32, 1024
    s_mov_b32 m0, s33
    s_add_u32 s34, s31, 32768
    s_nop 0
    buffer_load_dwordx4 v2, s[8:11], s34 offen lds
    s_mul_i32 s31, s29, 32*6144
    s_add_u32 s31, s31, s28
    s_mul_i32 s32, s20, 3072
    s_add_u32 s32, s32, s30
    s_add_u32 s32, s32, 8192
    s_add_u32 s33, s32, 0
    s_mov_b32 m0, s33
    s_nop 0
    buffer_load_dwordx4 v4, s[12:15], s31 offen lds
    s_add_u32 s33, s32, 1024
    s_mov_b32 m0, s33
    s_nop 0
    buffer_load_dwordx4 v5, s[12:15], s31 offen lds
    s_add_u32 s33, s32, 2048
    s_mov_b32 m0, s33
    s_nop 0
    buffer_load_dwordx4 v6, s[12:15], s31 offen lds
    s_add_u32 s29, s29, 1
    s_add_u32 s30, s30, 20480
    s_cmp_ge_u32 s30, 81920
    s_cselect_b32 s30, 0, s30
    s_lshl_b32 s31, s29, 6
    s_add_u32 s31, s31, s27
    s_lshl_b32 s32, s20, 11
    s_add_u32 s32, s32, s30
    s_add_u32 s33, s32, 0
    s_mov_b32 m0, s33
    s_add_u32 s34, s31, 0
    s_nop 0
    buffer_load_dwordx4 v2, s[8:11], s34 offen lds
    s_add_u32 s33, s32, 1024
    s_mov_b32 m0, s33
    s_add_u32 s34, s31, 32768
    s_nop 0
    buffer_load_dwordx4 v2, s[8:11], s34 offen lds
    s_mul_i32 s31, s29, 32*6144
    s_add_u32 s31, s31, s28
    s_mul_i32 s32, s20, 3072
    s_add_u32 s32, s32, s30
    s_add_u32 s32, s32, 8192
    s_add_u32 s33, s32, 0
    s_mov_b32 m0, s33
    s_nop 0
    buffer_load_dwordx4 v4, s[12:15], s31 offen lds
    s_add_u32 s33, s32, 1024
    s_mov_b32 m0, s33
    s_nop 0
    buffer_load_dwordx4 v5, s[12:15], s31 offen lds
    s_add_u32 s33, s32, 2048
    s_mov_b32 m0, s33
    s_nop 0
    buffer_load_dwordx4 v6, s[12:15], s31 offen lds
    s_add_u32 s29, s29, 1
    s_add_u32 s30, s30, 20480
    s_cmp_ge_u32 s30, 81920
    s_cselect_b32 s30, 0, s30
    s_lshl_b32 s31, s29, 6
    s_add_u32 s31, s31, s27
    s_lshl_b32 s32, s20, 11
    s_add_u32 s32, s32, s30
    s_add_u32 s33, s32, 0
    s_mov_b32 m0, s33
    s_add_u32 s34, s31, 0
    s_nop 0
    buffer_load_dwordx4 v2, s[8:11], s34 offen lds
    s_add_u32 s33, s32, 1024
    s_mov_b32 m0, s33
    s_add_u32 s34, s31, 32768
    s_nop 0
    buffer_load_dwordx4 v2, s[8:11], s34 offen lds
    s_mul_i32 s31, s29, 32*6144
    s_add_u32 s31, s31, s28
    s_mul_i32 s32, s20, 3072
    s_add_u32 s32, s32, s30
    s_add_u32 s32, s32, 8192
    s_add_u32 s33, s32, 0
    s_mov_b32 m0, s33
    s_nop 0
    buffer_load_dwordx4 v4, s[12:15], s31 offen lds
    s_add_u32 s33, s32, 1024
    s_mov_b32 m0, s33
    s_nop 0
    buffer_load_dwordx4 v5, s[12:15], s31 offen lds
    s_add_u32 s33, s32, 2048
    s_mov_b32 m0, s33
    s_nop 0
    buffer_load_dwordx4 v6, s[12:15], s31 offen lds
    s_add_u32 s29, s29, 1
    s_add_u32 s30, s30, 20480
    s_cmp_ge_u32 s30, 81920
    s_cselect_b32 s30, 0, s30
    s_mov_b32 s35, 0
    s_mov_b32 s36, 0
k1_qkv_loop:
    s_cmp_lt_u32 s35, 30
    s_cbranch_scc1 k1_qkv_wa
    s_cmp_lt_u32 s35, 31
    s_cbranch_scc1 k1_qkv_wb
    s_waitcnt vmcnt(0)
    s_branch k1_qkv_wd
k1_qkv_wb:
    s_waitcnt vmcnt(5)
    s_branch k1_qkv_wd
k1_qkv_wa:
    s_waitcnt vmcnt(10)
k1_qkv_wd:
    s_barrier
    s_cmp_lt_u32 s29, 32
    s_cbranch_scc0 k1_qkv_nodma
    s_lshl_b32 s31, s29, 6
    s_add_u32 s31, s31, s27
    s_lshl_b32 s32, s20, 11
    s_add_u32 s32, s32, s30
    s_add_u32 s33, s32, 0
    s_mov_b32 m0, s33
    s_add_u32 s34, s31, 0
    s_nop 0
    buffer_load_dwordx4 v2, s[8:11], s34 offen lds
    s_add_u32 s33, s32, 1024
    s_mov_b32 m0, s33
    s_add_u32 s34, s31, 32768
    s_nop 0
    buffer_load_dwordx4 v2, s[8:11], s34 offen lds
    s_mul_i32 s31, s29, 32*6144
    s_add_u32 s31, s31, s28
    s_mul_i32 s32, s20, 3072
    s_add_u32 s32, s32, s30
    s_add_u32 s32, s32, 8192
    s_add_u32 s33, s32, 0
    s_mov_b32 m0, s33
    s_nop 0
    buffer_load_dwordx4 v4, s[12:15], s31 offen lds
    s_add_u32 s33, s32, 1024
    s_mov_b32 m0, s33
    s_nop 0
    buffer_load_dwordx4 v5, s[12:15], s31 offen lds
    s_add_u32 s33, s32, 2048
    s_mov_b32 m0, s33
    s_nop 0
    buffer_load_dwordx4 v6, s[12:15], s31 offen lds
    s_add_u32 s29, s29, 1
    s_add_u32 s30, s30, 20480
    s_cmp_ge_u32 s30, 81920
    s_cselect_b32 s30, 0, s30
k1_qkv_nodma:
    v_add_u32 v17, s36, v12
    v_add_u32 v18, s36, v13
    v_add_u32 v21, s36, v16
    ds_read_b128 v[24:27], v17 offset:0
    ds_read_b128 v[28:31], v17 offset:2048
    ds_read_b64_tr_b16 v[32:33], v21 offset:0
    ds_read_b64_tr_b16 v[34:35], v21 offset:1536
    ds_read_b64_tr_b16 v[36:37], v21 offset:128
    ds_read_b64_tr_b16 v[38:39], v21 offset:1664
    ds_read_b64_tr_b16 v[40:41], v21 offset:256
    ds_read_b64_tr_b16 v[42:43], v21 offset:1792
    ds_read_b128 v[44:47], v18 offset:0
    ds_read_b128 v[48:51], v18 offset:2048
    ds_read_b64_tr_b16 v[52:53], v21 offset:6144
    ds_read_b64_tr_b16 v[54:55], v21 offset:7680
    ds_read_b64_tr_b16 v[56:57], v21 offset:6272
    ds_read_b64_tr_b16 v[58:59], v21 offset:7808
    ds_read_b64_tr_b16 v[60:61], v21 offset:6400
    ds_read_b64_tr_b16 v[62:63], v21 offset:7936
    s_waitcnt lgkmcnt(8)
    v_mfma_f32_32x32x16_bf16 v[64:79], v[32:35], v[24:27], v[64:79]
    v_mfma_f32_32x32x16_bf16 v[80:95], v[24:27], v[36:39], v[80:95]
    v_mfma_f32_32x32x16_bf16 v[96:111], v[24:27], v[40:43], v[96:111]
    v_mfma_f32_32x32x16_bf16 v[112:127], v[32:35], v[28:31], v[112:127]
    v_mfma_f32_32x32x16_bf16 v[128:143], v[28:31], v[36:39], v[128:143]
    v_mfma_f32_32x32x16_bf16 v[144:159], v[28:31], v[40:43], v[144:159]
    s_waitcnt lgkmcnt(0)
    v_mfma_f32_32x32x16_bf16 v[64:79], v[52:55], v[44:47], v[64:79]
    v_mfma_f32_32x32x16_bf16 v[80:95], v[44:47], v[56:59], v[80:95]
    v_mfma_f32_32x32x16_bf16 v[96:111], v[44:47], v[60:63], v[96:111]
    v_mfma_f32_32x32x16_bf16 v[112:127], v[52:55], v[48:51], v[112:127]
    v_mfma_f32_32x32x16_bf16 v[128:143], v[48:51], v[56:59], v[128:143]
    v_mfma_f32_32x32x16_bf16 v[144:159], v[48:51], v[60:63], v[144:159]
    s_add_u32 s36, s36, 20480
    s_cmp_ge_u32 s36, 81920
    s_cselect_b32 s36, 0, s36
    s_add_u32 s35, s35, 1
    s_cmp_lt_u32 s35, 32
    s_cbranch_scc1 k1_qkv_loop
    s_nop 7
    s_nop 7
    s_lshl_b32 s26, s21, 7
    s_lshl_b32 s27, s23, 6
    s_add_u32 s26, s26, s27
    v_add_u32 v20, s26, v7
    v_lshlrev_b32 v20, 11, v20
    v_lshl_add_u32 v20, v8, 3, v20
    s_lshl_b32 s26, s22, 7
    s_lshl_b32 s27, s24, 6
    s_add_u32 s26, s26, s27
    v_add_u32 v20, s26, v20
    v_cvt_pk_bf16_f32 v40, v64, v65
    v_lshlrev_b32 v41, 16, v40
    v_and_b32 v42, 0xffff0000, v40
    v_add_f32 v43, 1.0, v41
    v_add_f32 v44, 1.0, v42
    v_mul_f32 v45, s40, v41
    v_mul_f32 v46, s40, v42
    v_exp_f32 v45, v45
    v_exp_f32 v46, v46
    v_cvt_pk_bf16_f32 v43, v43, v44
    v_cmp_lt_f32 vcc, 0, v41
    v_cvt_pk_bf16_f32 v45, v45, v46
    v_lshlrev_b32 v44, 16, v43
    v_and_b32 v46, 0xffff0000, v43
    v_lshlrev_b32 v43, 16, v45
    v_and_b32 v45, 0xffff0000, v45
    v_cndmask_b32 v43, v43, v44, vcc
    v_cmp_lt_f32 vcc, 0, v42
    v_add_f32 v43, s42, v43
    s_nop 0
    v_cndmask_b32 v45, v45, v46, vcc
    v_add_f32 v45, s42, v45
    v_cvt_pk_bf16_f32 v22, v43, v45
    v_cvt_pk_bf16_f32 v40, v66, v67
    v_lshlrev_b32 v41, 16, v40
    v_and_b32 v42, 0xffff0000, v40
    v_add_f32 v43, 1.0, v41
    v_add_f32 v44, 1.0, v42
    v_mul_f32 v45, s40, v41
    v_mul_f32 v46, s40, v42
    v_exp_f32 v45, v45
    v_exp_f32 v46, v46
    v_cvt_pk_bf16_f32 v43, v43, v44
    v_cmp_lt_f32 vcc, 0, v41
    v_cvt_pk_bf16_f32 v45, v45, v46
    v_lshlrev_b32 v44, 16, v43
    v_and_b32 v46, 0xffff0000, v43
    v_lshlrev_b32 v43, 16, v45
    v_and_b32 v45, 0xffff0000, v45
    v_cndmask_b32 v43, v43, v44, vcc
    v_cmp_lt_f32 vcc, 0, v42
    v_add_f32 v43, s42, v43
    s_nop 0
    v_cndmask_b32 v45, v45, v46, vcc
    v_add_f32 v45, s42, v45
    v_cvt_pk_bf16_f32 v23, v43, v45
    buffer_store_dwordx2 v[22:23], v20, s[16:19], 0 offen offset:0
    s_nop 1
    v_cvt_pk_bf16_f32 v40, v68, v69
    v_lshlrev_b32 v41, 16, v40
    v_and_b32 v42, 0xffff0000, v40
    v_add_f32 v43, 1.0, v41
    v_add_f32 v44, 1.0, v42
    v_mul_f32 v45, s40, v41
    v_mul_f32 v46, s40, v42
    v_exp_f32 v45, v45
    v_exp_f32 v46, v46
    v_cvt_pk_bf16_f32 v43, v43, v44
    v_cmp_lt_f32 vcc, 0, v41
    v_cvt_pk_bf16_f32 v45, v45, v46
    v_lshlrev_b32 v44, 16, v43
    v_and_b32 v46, 0xffff0000, v43
    v_lshlrev_b32 v43, 16, v45
    v_and_b32 v45, 0xffff0000, v45
    v_cndmask_b32 v43, v43, v44, vcc
    v_cmp_lt_f32 vcc, 0, v42
    v_add_f32 v43, s42, v43
    s_nop 0
    v_cndmask_b32 v45, v45, v46, vcc
    v_add_f32 v45, s42, v45
    v_cvt_pk_bf16_f32 v22, v43, v45
    v_cvt_pk_bf16_f32 v40, v70, v71
    v_lshlrev_b32 v41, 16, v40
    v_and_b32 v42, 0xffff0000, v40
    v_add_f32 v43, 1.0, v41
    v_add_f32 v44, 1.0, v42
    v_mul_f32 v45, s40, v41
    v_mul_f32 v46, s40, v42
    v_exp_f32 v45, v45
    v_exp_f32 v46, v46
    v_cvt_pk_bf16_f32 v43, v43, v44
    v_cmp_lt_f32 vcc, 0, v41
    v_cvt_pk_bf16_f32 v45, v45, v46
    v_lshlrev_b32 v44, 16, v43
    v_and_b32 v46, 0xffff0000, v43
    v_lshlrev_b32 v43, 16, v45
    v_and_b32 v45, 0xffff0000, v45
    v_cndmask_b32 v43, v43, v44, vcc
    v_cmp_lt_f32 vcc, 0, v42
    v_add_f32 v43, s42, v43
    s_nop 0
    v_cndmask_b32 v45, v45, v46, vcc
    v_add_f32 v45, s42, v45
    v_cvt_pk_bf16_f32 v23, v43, v45
    buffer_store_dwordx2 v[22:23], v20, s[16:19], 0 offen offset:16
    s_nop 1
    v_cvt_pk_bf16_f32 v40, v72, v73
    v_lshlrev_b32 v41, 16, v40
    v_and_b32 v42, 0xffff0000, v40
    v_add_f32 v43, 1.0, v41
    v_add_f32 v44, 1.0, v42
    v_mul_f32 v45, s40, v41
    v_mul_f32 v46, s40, v42
    v_exp_f32 v45, v45
    v_exp_f32 v46, v46
    v_cvt_pk_bf16_f32 v43, v43, v44
    v_cmp_lt_f32 vcc, 0, v41
    v_cvt_pk_bf16_f32 v45, v45, v46
    v_lshlrev_b32 v44, 16, v43
    v_and_b32 v46, 0xffff0000, v43
    v_lshlrev_b32 v43, 16, v45
    v_and_b32 v45, 0xffff0000, v45
    v_cndmask_b32 v43, v43, v44, vcc
    v_cmp_lt_f32 vcc, 0, v42
    v_add_f32 v43, s42, v43
    s_nop 0
    v_cndmask_b32 v45, v45, v46, vcc
    v_add_f32 v45, s42, v45
    v_cvt_pk_bf16_f32 v22, v43, v45
    v_cvt_pk_bf16_f32 v40, v74, v75
    v_lshlrev_b32 v41, 16, v40
    v_and_b32 v42, 0xffff0000, v40
    v_add_f32 v43, 1.0, v41
    v_add_f32 v44, 1.0, v42
    v_mul_f32 v45, s40, v41
    v_mul_f32 v46, s40, v42
    v_exp_f32 v45, v45
    v_exp_f32 v46, v46
    v_cvt_pk_bf16_f32 v43, v43, v44
    v_cmp_lt_f32 vcc, 0, v41
    v_cvt_pk_bf16_f32 v45, v45, v46
    v_lshlrev_b32 v44, 16, v43
    v_and_b32 v46, 0xffff0000, v43
    v_lshlrev_b32 v43, 16, v45
    v_and_b32 v45, 0xffff0000, v45
    v_cndmask_b32 v43, v43, v44, vcc
    v_cmp_lt_f32 vcc, 0, v42
    v_add_f32 v43, s42, v43
    s_nop 0
    v_cndmask_b32 v45, v45, v46, vcc
    v_add_f32 v45, s42, v45
    v_cvt_pk_bf16_f32 v23, v43, v45
    buffer_store_dwordx2 v[22:23], v20, s[16:19], 0 offen offset:32
    s_nop 1
    v_cvt_pk_bf16_f32 v40, v76, v77
    v_lshlrev_b32 v41, 16, v40
    v_and_b32 v42, 0xffff0000, v40
    v_add_f32 v43, 1.0, v41
    v_add_f32 v44, 1.0, v42
    v_mul_f32 v45, s40, v41
    v_mul_f32 v46, s40, v42
    v_exp_f32 v45, v45
    v_exp_f32 v46, v46
    v_cvt_pk_bf16_f32 v43, v43, v44
    v_cmp_lt_f32 vcc, 0, v41
    v_cvt_pk_bf16_f32 v45, v45, v46
    v_lshlrev_b32 v44, 16, v43
    v_and_b32 v46, 0xffff0000, v43
    v_lshlrev_b32 v43, 16, v45
    v_and_b32 v45, 0xffff0000, v45
    v_cndmask_b32 v43, v43, v44, vcc
    v_cmp_lt_f32 vcc, 0, v42
    v_add_f32 v43, s42, v43
    s_nop 0
    v_cndmask_b32 v45, v45, v46, vcc
    v_add_f32 v45, s42, v45
    v_cvt_pk_bf16_f32 v22, v43, v45
    v_cvt_pk_bf16_f32 v40, v78, v79
    v_lshlrev_b32 v41, 16, v40
    v_and_b32 v42, 0xffff0000, v40
    v_add_f32 v43, 1.0, v41
    v_add_f32 v44, 1.0, v42
    v_mul_f32 v45, s40, v41
    v_mul_f32 v46, s40, v42
    v_exp_f32 v45, v45
    v_exp_f32 v46, v46
    v_cvt_pk_bf16_f32 v43, v43, v44
    v_cmp_lt_f32 vcc, 0, v41
    v_cvt_pk_bf16_f32 v45, v45, v46
    v_lshlrev_b32 v44, 16, v43
    v_and_b32 v46, 0xffff0000, v43
    v_lshlrev_b32 v43, 16, v45
    v_and_b32 v45, 0xffff0000, v45
    v_cndmask_b32 v43, v43, v44, vcc
    v_cmp_lt_f32 vcc, 0, v42
    v_add_f32 v43, s42, v43
    s_nop 0
    v_cndmask_b32 v45, v45, v46, vcc
    v_add_f32 v45, s42, v45
    v_cvt_pk_bf16_f32 v23, v43, v45
    buffer_store_dwordx2 v[22:23], v20, s[16:19], 0 offen offset:48
    s_nop 1
    v_cvt_pk_bf16_f32 v40, v112, v113
    v_lshlrev_b32 v41, 16, v40
    v_and_b32 v42, 0xffff0000, v40
    v_add_f32 v43, 1.0, v41
    v_add_f32 v44, 1.0, v42
    v_mul_f32 v45, s40, v41
    v_mul_f32 v46, s40, v42
    v_exp_f32 v45, v45
    v_exp_f32 v46, v46
    v_cvt_pk_bf16_f32 v43, v43, v44
    v_cmp_lt_f32 vcc, 0, v41
    v_cvt_pk_bf16_f32 v45, v45, v46
    v_lshlrev_b32 v44, 16, v43
    v_and_b32 v46, 0xffff0000, v43
    v_lshlrev_b32 v43, 16, v45
    v_and_b32 v45, 0xffff0000, v45
    v_cndmask_b32 v43, v43, v44, vcc
    v_cmp_lt_f32 vcc, 0, v42
    v_add_f32 v43, s42, v43
    s_nop 0
    v_cndmask_b32 v45, v45, v46, vcc
    v_add_f32 v45, s42, v45
    v_cvt_pk_bf16_f32 v22, v43, v45
    v_cvt_pk_bf16_f32 v40, v114, v115
    v_lshlrev_b32 v41, 16, v40
    v_and_b32 v42, 0xffff0000, v40
    v_add_f32 v43, 1.0, v41
    v_add_f32 v44, 1.0, v42
    v_mul_f32 v45, s40, v41
    v_mul_f32 v46, s40, v42
    v_exp_f32 v45, v45
    v_exp_f32 v46, v46
    v_cvt_pk_bf16_f32 v43, v43, v44
    v_cmp_lt_f32 vcc, 0, v41
    v_cvt_pk_bf16_f32 v45, v45, v46
    v_lshlrev_b32 v44, 16, v43
    v_and_b32 v46, 0xffff0000, v43
    v_lshlrev_b32 v43, 16, v45
    v_and_b32 v45, 0xffff0000, v45
    v_cndmask_b32 v43, v43, v44, vcc
    v_cmp_lt_f32 vcc, 0, v42
    v_add_f32 v43, s42, v43
    s_nop 0
    v_cndmask_b32 v45, v45, v46, vcc
    v_add_f32 v45, s42, v45
    v_cvt_pk_bf16_f32 v23, v43, v45
    s_mov_b32 s27, 65536
    buffer_store_dwordx2 v[22:23], v20, s[16:19], s27 offen offset:0
    s_nop 1
    v_cvt_pk_bf16_f32 v40, v116, v117
    v_lshlrev_b32 v41, 16, v40
    v_and_b32 v42, 0xffff0000, v40
    v_add_f32 v43, 1.0, v41
    v_add_f32 v44, 1.0, v42
    v_mul_f32 v45, s40, v41
    v_mul_f32 v46, s40, v42
    v_exp_f32 v45, v45
    v_exp_f32 v46, v46
    v_cvt_pk_bf16_f32 v43, v43, v44
    v_cmp_lt_f32 vcc, 0, v41
    v_cvt_pk_bf16_f32 v45, v45, v46
    v_lshlrev_b32 v44, 16, v43
    v_and_b32 v46, 0xffff0000, v43
    v_lshlrev_b32 v43, 16, v45
    v_and_b32 v45, 0xffff0000, v45
    v_cndmask_b32 v43, v43, v44, vcc
    v_cmp_lt_f32 vcc, 0, v42
    v_add_f32 v43, s42, v43
    s_nop 0
    v_cndmask_b32 v45, v45, v46, vcc
    v_add_f32 v45, s42, v45
    v_cvt_pk_bf16_f32 v22, v43, v45
    v_cvt_pk_bf16_f32 v40, v118, v119
    v_lshlrev_b32 v41, 16, v40
    v_and_b32 v42, 0xffff0000, v40
    v_add_f32 v43, 1.0, v41
    v_add_f32 v44, 1.0, v42
    v_mul_f32 v45, s40, v41
    v_mul_f32 v46, s40, v42
    v_exp_f32 v45, v45
    v_exp_f32 v46, v46
    v_cvt_pk_bf16_f32 v43, v43, v44
    v_cmp_lt_f32 vcc, 0, v41
    v_cvt_pk_bf16_f32 v45, v45, v46
    v_lshlrev_b32 v44, 16, v43
    v_and_b32 v46, 0xffff0000, v43
    v_lshlrev_b32 v43, 16, v45
    v_and_b32 v45, 0xffff0000, v45
    v_cndmask_b32 v43, v43, v44, vcc
    v_cmp_lt_f32 vcc, 0, v42
    v_add_f32 v43, s42, v43
    s_nop 0
    v_cndmask_b32 v45, v45, v46, vcc
    v_add_f32 v45, s42, v45
    v_cvt_pk_bf16_f32 v23, v43, v45
    s_mov_b32 s27, 65536
    buffer_store_dwordx2 v[22:23], v20, s[16:19], s27 offen offset:16
    s_nop 1
    v_cvt_pk_bf16_f32 v40, v120, v121
    v_lshlrev_b32 v41, 16, v40
    v_and_b32 v42, 0xffff0000, v40
    v_add_f32 v43, 1.0, v41
    v_add_f32 v44, 1.0, v42
    v_mul_f32 v45, s40, v41
    v_mul_f32 v46, s40, v42
    v_exp_f32 v45, v45
    v_exp_f32 v46, v46
    v_cvt_pk_bf16_f32 v43, v43, v44
    v_cmp_lt_f32 vcc, 0, v41
    v_cvt_pk_bf16_f32 v45, v45, v46
    v_lshlrev_b32 v44, 16, v43
    v_and_b32 v46, 0xffff0000, v43
    v_lshlrev_b32 v43, 16, v45
    v_and_b32 v45, 0xffff0000, v45
    v_cndmask_b32 v43, v43, v44, vcc
    v_cmp_lt_f32 vcc, 0, v42
    v_add_f32 v43, s42, v43
    s_nop 0
    v_cndmask_b32 v45, v45, v46, vcc
    v_add_f32 v45, s42, v45
    v_cvt_pk_bf16_f32 v22, v43, v45
    v_cvt_pk_bf16_f32 v40, v122, v123
    v_lshlrev_b32 v41, 16, v40
    v_and_b32 v42, 0xffff0000, v40
    v_add_f32 v43, 1.0, v41
    v_add_f32 v44, 1.0, v42
    v_mul_f32 v45, s40, v41
    v_mul_f32 v46, s40, v42
    v_exp_f32 v45, v45
    v_exp_f32 v46, v46
    v_cvt_pk_bf16_f32 v43, v43, v44
    v_cmp_lt_f32 vcc, 0, v41
    v_cvt_pk_bf16_f32 v45, v45, v46
    v_lshlrev_b32 v44, 16, v43
    v_and_b32 v46, 0xffff0000, v43
    v_lshlrev_b32 v43, 16, v45
    v_and_b32 v45, 0xffff0000, v45
    v_cndmask_b32 v43, v43, v44, vcc
    v_cmp_lt_f32 vcc, 0, v42
    v_add_f32 v43, s42, v43
    s_nop 0
    v_cndmask_b32 v45, v45, v46, vcc
    v_add_f32 v45, s42, v45
    v_cvt_pk_bf16_f32 v23, v43, v45
    s_mov_b32 s27, 65536
    buffer_store_dwordx2 v[22:23], v20, s[16:19], s27 offen offset:32
    s_nop 1
    v_cvt_pk_bf16_f32 v40, v124, v125
    v_lshlrev_b32 v41, 16, v40
    v_and_b32 v42, 0xffff0000, v40
    v_add_f32 v43, 1.0, v41
    v_add_f32 v44, 1.0, v42
    v_mul_f32 v45, s40, v41
    v_mul_f32 v46, s40, v42
    v_exp_f32 v45, v45
    v_exp_f32 v46, v46
    v_cvt_pk_bf16_f32 v43, v43, v44
    v_cmp_lt_f32 vcc, 0, v41
    v_cvt_pk_bf16_f32 v45, v45, v46
    v_lshlrev_b32 v44, 16, v43
    v_and_b32 v46, 0xffff0000, v43
    v_lshlrev_b32 v43, 16, v45
    v_and_b32 v45, 0xffff0000, v45
    v_cndmask_b32 v43, v43, v44, vcc
    v_cmp_lt_f32 vcc, 0, v42
    v_add_f32 v43, s42, v43
    s_nop 0
    v_cndmask_b32 v45, v45, v46, vcc
    v_add_f32 v45, s42, v45
    v_cvt_pk_bf16_f32 v22, v43, v45
    v_cvt_pk_bf16_f32 v40, v126, v127
    v_lshlrev_b32 v41, 16, v40
    v_and_b32 v42, 0xffff0000, v40
    v_add_f32 v43, 1.0, v41
    v_add_f32 v44, 1.0, v42
    v_mul_f32 v45, s40, v41
    v_mul_f32 v46, s40, v42
    v_exp_f32 v45, v45
    v_exp_f32 v46, v46
    v_cvt_pk_bf16_f32 v43, v43, v44
    v_cmp_lt_f32 vcc, 0, v41
    v_cvt_pk_bf16_f32 v45, v45, v46
    v_lshlrev_b32 v44, 16, v43
    v_and_b32 v46, 0xffff0000, v43
    v_lshlrev_b32 v43, 16, v45
    v_and_b32 v45, 0xffff0000, v45
    v_cndmask_b32 v43, v43, v44, vcc
    v_cmp_lt_f32 vcc, 0, v42
    v_add_f32 v43, s42, v43
    s_nop 0
    v_cndmask_b32 v45, v45, v46, vcc
    v_add_f32 v45, s42, v45
    v_cvt_pk_bf16_f32 v23, v43, v45
    s_mov_b32 s27, 65536
    buffer_store_dwordx2 v[22:23], v20, s[16:19], s27 offen offset:48
    s_nop 1
    v_mov_b32 v21, 0
    v_mov_b32 v48, 0
    v_mov_b32 v49, 0
    v_mov_b32 v50, 0
    v_mov_b32 v51, 0
    v_mov_b32 v52, 0
    v_mov_b32 v53, 0
    v_mov_b32 v54, 0
    v_mov_b32 v55, 0
    v_mov_b32 v56, 0
    v_mov_b32 v57, 0
    v_mov_b32 v58, 0
    v_mov_b32 v59, 0
    v_mov_b32 v60, 0
    v_mov_b32 v61, 0
    v_mov_b32 v62, 0
    v_mov_b32 v63, 0
    v_cvt_pk_bf16_f32 v40, v80, v81
    v_lshlrev_b32 v41, 16, v40
    v_and_b32 v42, 0xffff0000, v40
    v_add_f32 v43, 1.0, v41
    v_add_f32 v44, 1.0, v42
    v_mul_f32 v45, s40, v41
    v_mul_f32 v46, s40, v42
    v_exp_f32 v45, v45
    v_exp_f32 v46, v46
    v_cvt_pk_bf16_f32 v43, v43, v44
    v_cmp_lt_f32 vcc, 0, v41
    v_cvt_pk_bf16_f32 v45, v45, v46
    v_lshlrev_b32 v44, 16, v43
    v_and_b32 v46, 0xffff0000, v43
    v_lshlrev_b32 v43, 16, v45
    v_and_b32 v45, 0xffff0000, v45
    v_cndmask_b32 v43, v43, v44, vcc
    v_cmp_lt_f32 vcc, 0, v42
    v_add_f32 v43, s42, v43
    s_nop 0
    v_cndmask_b32 v45, v45, v46, vcc
    v_add_f32 v45, s42, v45
    v_cvt_pk_bf16_f32 v24, v43, v45
    v_lshlrev_b32 v22, 16, v24
    v_and_b32 v23, 0xffff0000, v24
    v_add_f32 v21, v21, v22
    v_add_f32 v21, v21, v23
    v_cvt_pk_bf16_f32 v28, v96, v97
    v_cvt_pk_bf16_f32 v40, v82, v83
    v_lshlrev_b32 v41, 16, v40
    v_and_b32 v42, 0xffff0000, v40
    v_add_f32 v43, 1.0, v41
    v_add_f32 v44, 1.0, v42
    v_mul_f32 v45, s40, v41
    v_mul_f32 v46, s40, v42
    v_exp_f32 v45, v45
    v_exp_f32 v46, v46
    v_cvt_pk_bf16_f32 v43, v43, v44
    v_cmp_lt_f32 vcc, 0, v41
    v_cvt_pk_bf16_f32 v45, v45, v46
    v_lshlrev_b32 v44, 16, v43
    v_and_b32 v46, 0xffff0000, v43
    v_lshlrev_b32 v43, 16, v45
    v_and_b32 v45, 0xffff0000, v45
    v_cndmask_b32 v43, v43, v44, vcc
    v_cmp_lt_f32 vcc, 0, v42
    v_add_f32 v43, s42, v43
    s_nop 0
    v_cndmask_b32 v45, v45, v46, vcc
    v_add_f32 v45, s42, v45
    v_cvt_pk_bf16_f32 v25, v43, v45
    v_lshlrev_b32 v22, 16, v25
    v_and_b32 v23, 0xffff0000, v25
    v_add_f32 v21, v21, v22
    v_add_f32 v21, v21, v23
    v_cvt_pk_bf16_f32 v29, v98, v99
    v_cvt_pk_bf16_f32 v40, v84, v85
    v_lshlrev_b32 v41, 16, v40
    v_and_b32 v42, 0xffff0000, v40
    v_add_f32 v43, 1.0, v41
    v_add_f32 v44, 1.0, v42
    v_mul_f32 v45, s40, v41
    v_mul_f32 v46, s40, v42
    v_exp_f32 v45, v45
    v_exp_f32 v46, v46
    v_cvt_pk_bf16_f32 v43, v43, v44
    v_cmp_lt_f32 vcc, 0, v41
    v_cvt_pk_bf16_f32 v45, v45, v46
    v_lshlrev_b32 v44, 16, v43
    v_and_b32 v46, 0xffff0000, v43
    v_lshlrev_b32 v43, 16, v45
    v_and_b32 v45, 0xffff0000, v45
    v_cndmask_b32 v43, v43, v44, vcc
    v_cmp_lt_f32 vcc, 0, v42
    v_add_f32 v43, s42, v43
    s_nop 0
    v_cndmask_b32 v45, v45, v46, vcc
    v_add_f32 v45, s42, v45
    v_cvt_pk_bf16_f32 v26, v43, v45
    v_lshlrev_b32 v22, 16, v26
    v_and_b32 v23, 0xffff0000, v26
    v_add_f32 v21, v21, v22
    v_add_f32 v21, v21, v23
    v_cvt_pk_bf16_f32 v30, v100, v101
    v_cvt_pk_bf16_f32 v40, v86, v87
    v_lshlrev_b32 v41, 16, v40
    v_and_b32 v42, 0xffff0000, v40
    v_add_f32 v43, 1.0, v41
    v_add_f32 v44, 1.0, v42
    v_mul_f32 v45, s40, v41
    v_mul_f32 v46, s40, v42
    v_exp_f32 v45, v45
    v_exp_f32 v46, v46
    v_cvt_pk_bf16_f32 v43, v43, v44
    v_cmp_lt_f32 vcc, 0, v41
    v_cvt_pk_bf16_f32 v45, v45, v46
    v_lshlrev_b32 v44, 16, v43
    v_and_b32 v46, 0xffff0000, v43
    v_lshlrev_b32 v43, 16, v45
    v_and_b32 v45, 0xffff0000, v45
    v_cndmask_b32 v43, v43, v44, vcc
    v_cmp_lt_f32 vcc, 0, v42
    v_add_f32 v43, s42, v43
    s_nop 0
    v_cndmask_b32 v45, v45, v46, vcc
    v_add_f32 v45, s42, v45
    v_cvt_pk_bf16_f32 v27, v43, v45
    v_lshlrev_b32 v22, 16, v27
    v_and_b32 v23, 0xffff0000, v27
    v_add_f32 v21, v21, v22
    v_add_f32 v21, v21, v23
    v_cvt_pk_bf16_f32 v31, v102, v103
    s_nop 1
    v_mfma_f32_32x32x16_bf16 v[48:63], v[24:27], v[28:31], v[48:63]
    s_nop 1
    v_cvt_pk_bf16_f32 v40, v88, v89
    v_lshlrev_b32 v41, 16, v40
    v_and_b32 v42, 0xffff0000, v40
    v_add_f32 v43, 1.0, v41
    v_add_f32 v44, 1.0, v42
    v_mul_f32 v45, s40, v41
    v_mul_f32 v46, s40, v42
    v_exp_f32 v45, v45
    v_exp_f32 v46, v46
    v_cvt_pk_bf16_f32 v43, v43, v44
    v_cmp_lt_f32 vcc, 0, v41
    v_cvt_pk_bf16_f32 v45, v45, v46
    v_lshlrev_b32 v44, 16, v43
    v_and_b32 v46, 0xffff0000, v43
    v_lshlrev_b32 v43, 16, v45
    v_and_b32 v45, 0xffff0000, v45
    v_cndmask_b32 v43, v43, v44, vcc
    v_cmp_lt_f32 vcc, 0, v42
    v_add_f32 v43, s42, v43
    s_nop 0
    v_cndmask_b32 v45, v45, v46, vcc
    v_add_f32 v45, s42, v45
    v_cvt_pk_bf16_f32 v24, v43, v45
    v_lshlrev_b32 v22, 16, v24
    v_and_b32 v23, 0xffff0000, v24
    v_add_f32 v21, v21, v22
    v_add_f32 v21, v21, v23
    v_cvt_pk_bf16_f32 v28, v104, v105
    v_cvt_pk_bf16_f32 v40, v90, v91
    v_lshlrev_b32 v41, 16, v40
    v_and_b32 v42, 0xffff0000, v40
    v_add_f32 v43, 1.0, v41
    v_add_f32 v44, 1.0, v42
    v_mul_f32 v45, s40, v41
    v_mul_f32 v46, s40, v42
    v_exp_f32 v45, v45
    v_exp_f32 v46, v46
    v_cvt_pk_bf16_f32 v43, v43, v44
    v_cmp_lt_f32 vcc, 0, v41
    v_cvt_pk_bf16_f32 v45, v45, v46
    v_lshlrev_b32 v44, 16, v43
    v_and_b32 v46, 0xffff0000, v43
    v_lshlrev_b32 v43, 16, v45
    v_and_b32 v45, 0xffff0000, v45
    v_cndmask_b32 v43, v43, v44, vcc
    v_cmp_lt_f32 vcc, 0, v42
    v_add_f32 v43, s42, v43
    s_nop 0
    v_cndmask_b32 v45, v45, v46, vcc
    v_add_f32 v45, s42, v45
    v_cvt_pk_bf16_f32 v25, v43, v45
    v_lshlrev_b32 v22, 16, v25
    v_and_b32 v23, 0xffff0000, v25
    v_add_f32 v21, v21, v22
    v_add_f32 v21, v21, v23
    v_cvt_pk_bf16_f32 v29, v106, v107
    v_cvt_pk_bf16_f32 v40, v92, v93
    v_lshlrev_b32 v41, 16, v40
    v_and_b32 v42, 0xffff0000, v40
    v_add_f32 v43, 1.0, v41
    v_add_f32 v44, 1.0, v42
    v_mul_f32 v45, s40, v41
    v_mul_f32 v46, s40, v42
    v_exp_f32 v45, v45
    v_exp_f32 v46, v46
    v_cvt_pk_bf16_f32 v43, v43, v44
    v_cmp_lt_f32 vcc, 0, v41
    v_cvt_pk_bf16_f32 v45, v45, v46
    v_lshlrev_b32 v44, 16, v43
    v_and_b32 v46, 0xffff0000, v43
    v_lshlrev_b32 v43, 16, v45
    v_and_b32 v45, 0xffff0000, v45
    v_cndmask_b32 v43, v43, v44, vcc
    v_cmp_lt_f32 vcc, 0, v42
    v_add_f32 v43, s42, v43
    s_nop 0
    v_cndmask_b32 v45, v45, v46, vcc
    v_add_f32 v45, s42, v45
    v_cvt_pk_bf16_f32 v26, v43, v45
    v_lshlrev_b32 v22, 16, v26
    v_and_b32 v23, 0xffff0000, v26
    v_add_f32 v21, v21, v22
    v_add_f32 v21, v21, v23
    v_cvt_pk_bf16_f32 v30, v108, v109
    v_cvt_pk_bf16_f32 v40, v94, v95
    v_lshlrev_b32 v41, 16, v40
    v_and_b32 v42, 0xffff0000, v40
    v_add_f32 v43, 1.0, v41
    v_add_f32 v44, 1.0, v42
    v_mul_f32 v45, s40, v41
    v_mul_f32 v46, s40, v42
    v_exp_f32 v45, v45
    v_exp_f32 v46, v46
    v_cvt_pk_bf16_f32 v43, v43, v44
    v_cmp_lt_f32 vcc, 0, v41
    v_cvt_pk_bf16_f32 v45, v45, v46
    v_lshlrev_b32 v44, 16, v43
    v_and_b32 v46, 0xffff0000, v43
    v_lshlrev_b32 v43, 16, v45
    v_and_b32 v45, 0xffff0000, v45
    v_cndmask_b32 v43, v43, v44, vcc
    v_cmp_lt_f32 vcc, 0, v42
    v_add_f32 v43, s42, v43
    s_nop 0
    v_cndmask_b32 v45, v45, v46, vcc
    v_add_f32 v45, s42, v45
    v_cvt_pk_bf16_f32 v27, v43, v45
    v_lshlrev_b32 v22, 16, v27
    v_and_b32 v23, 0xffff0000, v27
    v_add_f32 v21, v21, v22
    v_add_f32 v21, v21, v23
    v_cvt_pk_bf16_f32 v31, v110, v111
    s_nop 1
    v_mfma_f32_32x32x16_bf16 v[48:63], v[24:27], v[28:31], v[48:63]
    s_nop 1
    v_cvt_pk_bf16_f32 v40, v128, v129
    v_lshlrev_b32 v41, 16, v40
    v_and_b32 v42, 0xffff0000, v40
    v_add_f32 v43, 1.0, v41
    v_add_f32 v44, 1.0, v42
    v_mul_f32 v45, s40, v41
    v_mul_f32 v46, s40, v42
    v_exp_f32 v45, v45
    v_exp_f32 v46, v46
    v_cvt_pk_bf16_f32 v43, v43, v44
    v_cmp_lt_f32 vcc, 0, v41
    v_cvt_pk_bf16_f32 v45, v45, v46
    v_lshlrev_b32 v44, 16, v43
    v_and_b32 v46, 0xffff0000, v43
    v_lshlrev_b32 v43, 16, v45
    v_and_b32 v45, 0xffff0000, v45
    v_cndmask_b32 v43, v43, v44, vcc
    v_cmp_lt_f32 vcc, 0, v42
    v_add_f32 v43, s42, v43
    s_nop 0
    v_cndmask_b32 v45, v45, v46, vcc
    v_add_f32 v45, s42, v45
    v_cvt_pk_bf16_f32 v24, v43, v45
    v_lshlrev_b32 v22, 16, v24
    v_and_b32 v23, 0xffff0000, v24
    v_add_f32 v21, v21, v22
    v_add_f32 v21, v21, v23
    v_cvt_pk_bf16_f32 v28, v144, v145
    v_cvt_pk_bf16_f32 v40, v130, v131
    v_lshlrev_b32 v41, 16, v40
    v_and_b32 v42, 0xffff0000, v40
    v_add_f32 v43, 1.0, v41
    v_add_f32 v44, 1.0, v42
    v_mul_f32 v45, s40, v41
    v_mul_f32 v46, s40, v42
    v_exp_f32 v45, v45
    v_exp_f32 v46, v46
    v_cvt_pk_bf16_f32 v43, v43, v44
    v_cmp_lt_f32 vcc, 0, v41
    v_cvt_pk_bf16_f32 v45, v45, v46
    v_lshlrev_b32 v44, 16, v43
    v_and_b32 v46, 0xffff0000, v43
    v_lshlrev_b32 v43, 16, v45
    v_and_b32 v45, 0xffff0000, v45
    v_cndmask_b32 v43, v43, v44, vcc
    v_cmp_lt_f32 vcc, 0, v42
    v_add_f32 v43, s42, v43
    s_nop 0
    v_cndmask_b32 v45, v45, v46, vcc
    v_add_f32 v45, s42, v45
    v_cvt_pk_bf16_f32 v25, v43, v45
    v_lshlrev_b32 v22, 16, v25
    v_and_b32 v23, 0xffff0000, v25
    v_add_f32 v21, v21, v22
    v_add_f32 v21, v21, v23
    v_cvt_pk_bf16_f32 v29, v146, v147
    v_cvt_pk_bf16_f32 v40, v132, v133
    v_lshlrev_b32 v41, 16, v40
    v_and_b32 v42, 0xffff0000, v40
    v_add_f32 v43, 1.0, v41
    v_add_f32 v44, 1.0, v42
    v_mul_f32 v45, s40, v41
    v_mul_f32 v46, s40, v42
    v_exp_f32 v45, v45
    v_exp_f32 v46, v46
    v_cvt_pk_bf16_f32 v43, v43, v44
    v_cmp_lt_f32 vcc, 0, v41
    v_cvt_pk_bf16_f32 v45, v45, v46
    v_lshlrev_b32 v44, 16, v43
    v_and_b32 v46, 0xffff0000, v43
    v_lshlrev_b32 v43, 16, v45
    v_and_b32 v45, 0xffff0000, v45
    v_cndmask_b32 v43, v43, v44, vcc
    v_cmp_lt_f32 vcc, 0, v42
    v_add_f32 v43, s42, v43
    s_nop 0
    v_cndmask_b32 v45, v45, v46, vcc
    v_add_f32 v45, s42, v45
    v_cvt_pk_bf16_f32 v26, v43, v45
    v_lshlrev_b32 v22, 16, v26
    v_and_b32 v23, 0xffff0000, v26
    v_add_f32 v21, v21, v22
    v_add_f32 v21, v21, v23
    v_cvt_pk_bf16_f32 v30, v148, v149
    v_cvt_pk_bf16_f32 v40, v134, v135
    v_lshlrev_b32 v41, 16, v40
    v_and_b32 v42, 0xffff0000, v40
    v_add_f32 v43, 1.0, v41
    v_add_f32 v44, 1.0, v42
    v_mul_f32 v45, s40, v41
    v_mul_f32 v46, s40, v42
    v_exp_f32 v45, v45
    v_exp_f32 v46, v46
    v_cvt_pk_bf16_f32 v43, v43, v44
    v_cmp_lt_f32 vcc, 0, v41
    v_cvt_pk_bf16_f32 v45, v45, v46
    v_lshlrev_b32 v44, 16, v43
    v_and_b32 v46, 0xffff0000, v43
    v_lshlrev_b32 v43, 16, v45
    v_and_b32 v45, 0xffff0000, v45
    v_cndmask_b32 v43, v43, v44, vcc
    v_cmp_lt_f32 vcc, 0, v42
    v_add_f32 v43, s42, v43
    s_nop 0
    v_cndmask_b32 v45, v45, v46, vcc
    v_add_f32 v45, s42, v45
    v_cvt_pk_bf16_f32 v27, v43, v45
    v_lshlrev_b32 v22, 16, v27
    v_and_b32 v23, 0xffff0000, v27
    v_add_f32 v21, v21, v22
    v_add_f32 v21, v21, v23
    v_cvt_pk_bf16_f32 v31, v150, v151
    s_nop 1
    v_mfma_f32_32x32x16_bf16 v[48:63], v[24:27], v[28:31], v[48:63]
    s_nop 1
    v_cvt_pk_bf16_f32 v40, v136, v137
    v_lshlrev_b32 v41, 16, v40
    v_and_b32 v42, 0xffff0000, v40
    v_add_f32 v43, 1.0, v41
    v_add_f32 v44, 1.0, v42
    v_mul_f32 v45, s40, v41
    v_mul_f32 v46, s40, v42
    v_exp_f32 v45, v45
    v_exp_f32 v46, v46
    v_cvt_pk_bf16_f32 v43, v43, v44
    v_cmp_lt_f32 vcc, 0, v41
    v_cvt_pk_bf16_f32 v45, v45, v46
    v_lshlrev_b32 v44, 16, v43
    v_and_b32 v46, 0xffff0000, v43
    v_lshlrev_b32 v43, 16, v45
    v_and_b32 v45, 0xffff0000, v45
    v_cndmask_b32 v43, v43, v44, vcc
    v_cmp_lt_f32 vcc, 0, v42
    v_add_f32 v43, s42, v43
    s_nop 0
    v_cndmask_b32 v45, v45, v46, vcc
    v_add_f32 v45, s42, v45
    v_cvt_pk_bf16_f32 v24, v43, v45
    v_lshlrev_b32 v22, 16, v24
    v_and_b32 v23, 0xffff0000, v24
    v_add_f32 v21, v21, v22
    v_add_f32 v21, v21, v23
    v_cvt_pk_bf16_f32 v28, v152, v153
    v_cvt_pk_bf16_f32 v40, v138, v139
    v_lshlrev_b32 v41, 16, v40
    v_and_b32 v42, 0xffff0000, v40
    v_add_f32 v43, 1.0, v41
    v_add_f32 v44, 1.0, v42
    v_mul_f32 v45, s40, v41
    v_mul_f32 v46, s40, v42
    v_exp_f32 v45, v45
    v_exp_f32 v46, v46
    v_cvt_pk_bf16_f32 v43, v43, v44
    v_cmp_lt_f32 vcc, 0, v41
    v_cvt_pk_bf16_f32 v45, v45, v46
    v_lshlrev_b32 v44, 16, v43
    v_and_b32 v46, 0xffff0000, v43
    v_lshlrev_b32 v43, 16, v45
    v_and_b32 v45, 0xffff0000, v45
    v_cndmask_b32 v43, v43, v44, vcc
    v_cmp_lt_f32 vcc, 0, v42
    v_add_f32 v43, s42, v43
    s_nop 0
    v_cndmask_b32 v45, v45, v46, vcc
    v_add_f32 v45, s42, v45
    v_cvt_pk_bf16_f32 v25, v43, v45
    v_lshlrev_b32 v22, 16, v25
    v_and_b32 v23, 0xffff0000, v25
    v_add_f32 v21, v21, v22
    v_add_f32 v21, v21, v23
    v_cvt_pk_bf16_f32 v29, v154, v155
    v_cvt_pk_bf16_f32 v40, v140, v141
    v_lshlrev_b32 v41, 16, v40
    v_and_b32 v42, 0xffff0000, v40
    v_add_f32 v43, 1.0, v41
    v_add_f32 v44, 1.0, v42
    v_mul_f32 v45, s40, v41
    v_mul_f32 v46, s40, v42
    v_exp_f32 v45, v45
    v_exp_f32 v46, v46
    v_cvt_pk_bf16_f32 v43, v43, v44
    v_cmp_lt_f32 vcc, 0, v41
    v_cvt_pk_bf16_f32 v45, v45, v46
    v_lshlrev_b32 v44, 16, v43
    v_and_b32 v46, 0xffff0000, v43
    v_lshlrev_b32 v43, 16, v45
    v_and_b32 v45, 0xffff0000, v45
    v_cndmask_b32 v43, v43, v44, vcc
    v_cmp_lt_f32 vcc, 0, v42
    v_add_f32 v43, s42, v43
    s_nop 0
    v_cndmask_b32 v45, v45, v46, vcc
    v_add_f32 v45, s42, v45
    v_cvt_pk_bf16_f32 v26, v43, v45
    v_lshlrev_b32 v22, 16, v26
    v_and_b32 v23, 0xffff0000, v26
    v_add_f32 v21, v21, v22
    v_add_f32 v21, v21, v23
    v_cvt_pk_bf16_f32 v30, v156, v157
    v_cvt_pk_bf16_f32 v40, v142, v143
    v_lshlrev_b32 v41, 16, v40
    v_and_b32 v42, 0xffff0000, v40
    v_add_f32 v43, 1.0, v41
    v_add_f32 v44, 1.0, v42
    v_mul_f32 v45, s40, v41
    v_mul_f32 v46, s40, v42
    v_exp_f32 v45, v45
    v_exp_f32 v46, v46
    v_cvt_pk_bf16_f32 v43, v43, v44
    v_cmp_lt_f32 vcc, 0, v41
    v_cvt_pk_bf16_f32 v45, v45, v46
    v_lshlrev_b32 v44, 16, v43
    v_and_b32 v46, 0xffff0000, v43
    v_lshlrev_b32 v43, 16, v45
    v_and_b32 v45, 0xffff0000, v45
    v_cndmask_b32 v43, v43, v44, vcc
    v_cmp_lt_f32 vcc, 0, v42
    v_add_f32 v43, s42, v43
    s_nop 0
    v_cndmask_b32 v45, v45, v46, vcc
    v_add_f32 v45, s42, v45
    v_cvt_pk_bf16_f32 v27, v43, v45
    v_lshlrev_b32 v22, 16, v27
    v_and_b32 v23, 0xffff0000, v27
    v_add_f32 v21, v21, v22
    v_add_f32 v21, v21, v23
    v_cvt_pk_bf16_f32 v31, v158, v159
    s_nop 1
    v_mfma_f32_32x32x16_bf16 v[48:63], v[24:27], v[28:31], v[48:63]
    s_nop 1
    s_nop 7
    s_nop 3
    s_barrier
    v_lshlrev_b32 v22, 2, v1
    s_lshl_b32 s26, s24, 13
    v_add_u32 v22, s26, v22
    s_cmp_eq_u32 s23, 0
    s_cbranch_scc1 k1_qkv_red0
    ds_write_b32 v22, v48 offset:0
    ds_write_b32 v22, v49 offset:256
    ds_write_b32 v22, v50 offset:512
    ds_write_b32 v22, v51 offset:768
    ds_write_b32 v22, v52 offset:1024
    ds_write_b32 v22, v53 offset:1280
    ds_write_b32 v22, v54 offset:1536
    ds_write_b32 v22, v55 offset:1792
    ds_write_b32 v22, v56 offset:2048
    ds_write_b32 v22, v57 offset:2304
    ds_write_b32 v22, v58 offset:2560
    ds_write_b32 v22, v59 offset:2816
    ds_write_b32 v22, v60 offset:3072
    ds_write_b32 v22, v61 offset:3328
    ds_write_b32 v22, v62 offset:3584
    ds_write_b32 v22, v63 offset:3840
    ds_write_b32 v22, v21 offset:4096
    s_waitcnt lgkmcnt(0)
    s_barrier
    s_endpgm
k1_qkv_red0:
    s_barrier
    ds_read_b32 v24, v22 offset:0
    ds_read_b32 v25, v22 offset:256
    ds_read_b32 v26, v22 offset:512
    ds_read_b32 v27, v22 offset:768
    ds_read_b32 v28, v22 offset:1024
    ds_read_b32 v29, v22 offset:1280
    ds_read_b32 v30, v22 offset:1536
    ds_read_b32 v31, v22 offset:1792
    ds_read_b32 v32, v22 offset:2048
    ds_read_b32 v33, v22 offset:2304
    ds_read_b32 v34, v22 offset:2560
    ds_read_b32 v35, v22 offset:2816
    ds_read_b32 v36, v22 offset:3072
    ds_read_b32 v37, v22 offset:3328
    ds_read_b32 v38, v22 offset:3584
    ds_read_b32 v39, v22 offset:3840
    ds_read_b32 v23, v22 offset:4096
    s_waitcnt lgkmcnt(0)
    v_add_f32 v48, v48, v24
    v_add_f32 v49, v49, v25
    v_add_f32 v50, v50, v26
    v_add_f32 v51, v51, v27
    v_add_f32 v52, v52, v28
    v_add_f32 v53, v53, v29
    v_add_f32 v54, v54, v30
    v_add_f32 v55, v55, v31
    v_add_f32 v56, v56, v32
    v_add_f32 v57, v57, v33
    v_add_f32 v58, v58, v34
    v_add_f32 v59, v59, v35
    v_add_f32 v60, v60, v36
    v_add_f32 v61, v61, v37
    v_add_f32 v62, v62, v38
    v_add_f32 v63, v63, v39
    v_add_f32 v21, v21, v23
    s_mov_b32 s26, s21
    s_lshl_b32 s27, s22, 1
    s_add_u32 s27, s27, s24
    s_lshl_b32 s28, s26, 5
    s_add_u32 s28, s28, s27
    s_lshl_b32 s28, s28, 12
    v_lshlrev_b32 v22, 2, v7
    v_lshl_add_u32 v22, v8, 9, v22
    v_add_u32 v22, s28, v22
    buffer_store_dword v48, v22, s[60:63], 0 offen offset:0
    buffer_store_dword v49, v22, s[60:63], 0 offen offset:128
    buffer_store_dword v50, v22, s[60:63], 0 offen offset:256
    buffer_store_dword v51, v22, s[60:63], 0 offen offset:384
    buffer_store_dword v52, v22, s[60:63], 0 offen offset:1024
    buffer_store_dword v53, v22, s[60:63], 0 offen offset:1152
    buffer_store_dword v54, v22, s[60:63], 0 offen offset:1280
    buffer_store_dword v55, v22, s[60:63], 0 offen offset:1408
    buffer_store_dword v56, v22, s[60:63], 0 offen offset:2048
    buffer_store_dword v57, v22, s[60:63], 0 offen offset:2176
    buffer_store_dword v58, v22, s[60:63], 0 offen offset:2304
    buffer_store_dword v59, v22, s[60:63], 0 offen offset:2432
    buffer_store_dword v60, v22, s[60:63], 0 offen offset:3072
    buffer_store_dword v61, v22, s[60:63], 0 offen offset:3200
    buffer_store_dword v62, v22, s[60:63], 0 offen offset:3328
    buffer_store_dword v63, v22, s[60:63], 0 offen offset:3456
    s_lshl_b32 s28, s26, 13
    s_lshl_b32 s29, s27, 7
    s_add_u32 s28, s28, s29
    v_lshlrev_b32 v22, 2, v7
    v_lshl_add_u32 v22, v8, 12, v22
    v_add_u32 v22, s28, v22
    buffer_store_dword v21, v22, s[64:67], 0 offen
    s_endpgm
k1_kg:
    s_load_dwordx4 s[44:47], s[0:1], 8
    s_load_dwordx4 s[48:51], s[0:1], 24
    s_load_dwordx4 s[52:55], s[0:1], 40
    s_load_dwordx2 s[56:57], s[0:1], 56
    s_waitcnt lgkmcnt(0)
    s_mov_b32 s60, s44
    s_and_b32 s61, s45, 0xffff
    s_mov_b32 s62, 0x40000
    s_mov_b32 s63, 0x00020000
    s_mov_b32 s64, s46
    s_and_b32 s65, s47, 0xffff
    s_mov_b32 s66, 0x40000
    s_mov_b32 s67, 0x00020000
    s_mov_b32 s68, s48
    s_and_b32 s69, s49, 0xffff
    s_mov_b32 s70, 0x40000
    s_mov_b32 s71, 0x00020000
    s_mov_b32 s72, s50
    s_and_b32 s73, s51, 0xffff
    s_mov_b32 s74, 0x40000
    s_mov_b32 s75, 0x00020000
    s_mov_b32 s76, s52
    s_and_b32 s77, s53, 0xffff
    s_mov_b32 s78, 0x40000
    s_mov_b32 s79, 0x00020000
    s_mov_b32 s80, s54
    s_and_b32 s81, s55, 0xffff
    s_mov_b32 s82, 0x40000
    s_mov_b32 s83, 0x00020000
    s_mov_b32 s84, s56
    s_and_b32 s85, s57, 0xffff
    s_mov_b32 s86, 0x800
    s_mov_b32 s87, 0x00020000
    s_add_u32 s12, s6, 0x400000
    s_addc_u32 s13, s7, 0
    s_and_b32 s13, s13, 0xffff
    s_mov_b32 s14, 0x500000
    s_mov_b32 s15, 0x00020000
    s_mov_b32 s40, 0x3fb8aa3b
    s_mov_b32 s41, 0x3e22f983
    v_and_b32 v1, 63, v0
    v_lshrrev_b32 v2, 6, v0
    s_nop 1
    v_readfirstlane_b32 s20, v2
    s_nop 3
    s_lshl_b32 s21, s2, 2
    s_add_u32 s21, s21, s20
    s_mul_i32 s22, s20, 18944
    s_lshl_b32 s23, s21, 1
    v_mov_b32 v3, s23
    buffer_load_ushort v4, v3, s[84:87], 0 offen
    v_and_b32 v5, 15, v1
    v_lshrrev_b32 v6, 4, v1
    v_cvt_f32_u32 v7, v5
    v_mul_f32 v8, 16.0, v7
    v_add_f32 v9, v8, v8
    v_add_f32 v9, 0x43800000, v9
    v_lshlrev_b32 v10, 6, v6
    s_lshl_b32 s23, s21, 8
    v_add_u32 v10, s23, v10
    s_waitcnt vmcnt(0)
    v_lshlrev_b32 v4, 16, v4
    v_mul_f32 v4, s40, v4
    v_exp_f32 v4, v4
    s_nop 0
    v_cvt_pk_bf16_f32 v4, v4, v4
    v_lshlrev_b32 v4, 16, v4
    v_mov_b32 v64, 0
    v_mov_b32 v65, 0
    v_mov_b32 v66, 0
    v_mov_b32 v67, 0
    v_mov_b32 v68, 0
    v_mov_b32 v69, 0
    v_mov_b32 v70, 0
    v_mov_b32 v71, 0
    v_mov_b32 v72, 0
    v_mov_b32 v73, 0
    v_mov_b32 v74, 0
    v_mov_b32 v75, 0
    v_mov_b32 v76, 0
    v_mov_b32 v77, 0
    v_mov_b32 v78, 0
    v_mov_b32 v79, 0
    buffer_load_ushort v12, v10, s[60:63], 0 offen
    buffer_load_ushort v13, v10, s[64:67], 0 offen
    buffer_load_ushort v14, v10, s[68:71], 0 offen
    buffer_load_ushort v15, v10, s[72:75], 0 offen
    buffer_load_ushort v16, v10, s[76:79], 0 offen
    buffer_load_ushort v17, v10, s[80:83], 0 offen
    s_mov_b32 s26, 0
k1_kg_loop:
    s_waitcnt vmcnt(0)
    v_lshlrev_b32 v18, 16, v12
    v_lshlrev_b32 v19, 16, v13
    v_lshlrev_b32 v20, 16, v14
    v_lshlrev_b32 v21, 16, v15
    v_lshlrev_b32 v22, 16, v16
    v_lshlrev_b32 v23, 16, v17
    v_add_u32 v10, 2, v10
    s_cmp_lt_u32 s26, 31
    s_cbranch_scc0 k1_kg_nopf
    buffer_load_ushort v12, v10, s[60:63], 0 offen
    buffer_load_ushort v13, v10, s[64:67], 0 offen
    buffer_load_ushort v14, v10, s[68:71], 0 offen
    buffer_load_ushort v15, v10, s[72:75], 0 offen
    buffer_load_ushort v16, v10, s[76:79], 0 offen
    buffer_load_ushort v17, v10, s[80:83], 0 offen
k1_kg_nopf:
    v_mul_f32 v18, v4, v18
    v_mul_f32 v19, v4, v19
    v_mul_f32 v20, v4, v20
    v_mul_f32 v21, v4, v21
    v_mul_f32 v24, v22, v20
    v_mul_f32 v25, v22, v21
    v_fma_f32 v24, -v23, v21, v24
    v_fma_f32 v25, v23, v20, v25
    v_mul_f32 v60, v18, v7
    v_mul_f32 v61, v19, v7
    v_mul_f32 v60, s40, v60
    v_mul_f32 v61, s41, v61
    v_exp_f32 v60, v60
    v_fract_f32 v61, v61
    v_cos_f32 v26, v61
    v_sin_f32 v27, v61
    s_nop 0
    v_mul_f32 v26, v26, v60
    v_mul_f32 v27, v27, v60
    v_mul_f32 v60, v18, v8
    v_mul_f32 v61, v19, v8
    v_mul_f32 v60, s40, v60
    v_mul_f32 v61, s41, v61
    v_exp_f32 v60, v60
    v_fract_f32 v61, v61
    v_cos_f32 v34, v61
    v_sin_f32 v35, v61
    s_nop 0
    v_mul_f32 v34, v34, v60
    v_mul_f32 v35, v35, v60
    v_mul_f32 v60, v18, v9
    v_mul_f32 v61, v19, v9
    v_mul_f32 v60, s40, v60
    v_mul_f32 v61, s41, v61
    v_exp_f32 v60, v60
    v_fract_f32 v61, v61
    v_cos_f32 v36, v61
    v_sin_f32 v37, v61
    s_nop 0
    v_mul_f32 v36, v36, v60
    v_mul_f32 v37, v37, v60
    v_mul_f32 v60, v27, v27
    v_mul_f32 v29, v26, v27
    v_fma_f32 v28, v26, v26, -v60
    v_add_f32 v29, v29, v29
    v_mul_f32 v61, v37, v37
    v_mul_f32 v39, v36, v37
    v_fma_f32 v38, v36, v36, -v61
    v_add_f32 v39, v39, v39
    v_mul_f32 v60, v29, v29
    v_mul_f32 v31, v28, v29
    v_fma_f32 v30, v28, v28, -v60
    v_add_f32 v31, v31, v31
    v_mul_f32 v61, v39, v39
    v_mul_f32 v41, v38, v39
    v_fma_f32 v40, v38, v38, -v61
    v_add_f32 v41, v41, v41
    v_mul_f32 v60, v31, v31
    v_mul_f32 v33, v30, v31
    v_fma_f32 v32, v30, v30, -v60
    v_add_f32 v33, v33, v33
    v_mul_f32 v42, v24, v34
    v_mul_f32 v43, v24, v35
    v_fma_f32 v42, -v25, v35, v42
    v_fma_f32 v43, v25, v34, v43
    v_mul_f32 v44, v24, v36
    v_mul_f32 v45, v24, v37
    v_fma_f32 v44, -v25, v37, v44
    v_fma_f32 v45, v25, v36, v45
    v_mul_f32 v46, v24, v38
    v_mul_f32 v47, v24, v39
    v_fma_f32 v46, -v25, v39, v46
    v_fma_f32 v47, v25, v38, v47
    v_mul_f32 v48, v24, v40
    v_mul_f32 v49, v24, v41
    v_fma_f32 v48, -v25, v41, v48
    v_fma_f32 v49, v25, v40, v49
    v_xor_b32 v27, 0x80000000, v27
    v_xor_b32 v29, 0x80000000, v29
    v_xor_b32 v31, 0x80000000, v31
    v_xor_b32 v33, 0x80000000, v33
    s_nop 1
    v_mfma_f32_16x16x4_f32 v[64:67], v42, v26, v[64:67]
    v_mfma_f32_16x16x4_f32 v[68:71], v44, v28, v[68:71]
    v_mfma_f32_16x16x4_f32 v[72:75], v46, v30, v[72:75]
    v_mfma_f32_16x16x4_f32 v[76:79], v48, v32, v[76:79]
    v_mfma_f32_16x16x4_f32 v[64:67], v43, v27, v[64:67]
    v_mfma_f32_16x16x4_f32 v[68:71], v45, v29, v[68:71]
    v_mfma_f32_16x16x4_f32 v[72:75], v47, v31, v[72:75]
    v_mfma_f32_16x16x4_f32 v[76:79], v49, v33, v[76:79]
    s_add_u32 s26, s26, 1
    s_cmp_lt_u32 s26, 32
    s_cbranch_scc1 k1_kg_loop
    s_nop 7
    s_nop 7
    v_lshlrev_b32 v11, 6, v6
    v_add_u32 v11, v11, v5
    v_lshlrev_b32 v12, 2, v11
    v_add_u32 v12, s22, v12
    ds_write_b32 v12, v64 offset:0
    ds_write_b32 v12, v65 offset:64
    ds_write_b32 v12, v66 offset:128
    ds_write_b32 v12, v67 offset:192
    v_lshlrev_b32 v12, 3, v11
    v_add_u32 v12, s22, v12
    ds_write_b32 v12, v68 offset:1024
    ds_write_b32 v12, v69 offset:1152
    ds_write_b32 v12, v70 offset:1280
    ds_write_b32 v12, v71 offset:1408
    v_lshlrev_b32 v12, 4, v11
    v_add_u32 v12, s22, v12
    ds_write_b32 v12, v72 offset:2048
    ds_write_b32 v12, v73 offset:2304
    ds_write_b32 v12, v74 offset:2560
    ds_write_b32 v12, v75 offset:2816
    v_lshlrev_b32 v12, 5, v11
    v_add_u32 v12, s22, v12
    ds_write_b32 v12, v76 offset:4096
    ds_write_b32 v12, v77 offset:4608
    ds_write_b32 v12, v78 offset:5120
    ds_write_b32 v12, v79 offset:5632
    s_waitcnt lgkmcnt(0)
    s_mul_i32 s23, s21, 5120
    v_lshlrev_b32 v13, 4, v1
    v_add_u32 v13, s23, v13
    v_lshlrev_b32 v14, 3, v1
    v_lshlrev_b32 v15, 4, v1
    v_add_u32 v15, s22, v15
    v_sub_u32 v20, 2047, v14
    v_max_i32 v50, 0, v20
    v_cvt_f32_u32 v50, v50
    v_cvt_pk_bf16_f32 v50, v50, v50
    v_lshlrev_b32 v50, 16, v50
    v_cvt_u32_f32 v50, v50
    v_lshlrev_b32 v50, 2, v50
    v_add_u32 v50, s22, v50
    v_sub_u32 v21, 2046, v14
    v_max_i32 v51, 0, v21
    v_cvt_f32_u32 v51, v51
    v_cvt_pk_bf16_f32 v51, v51, v51
    v_lshlrev_b32 v51, 16, v51
    v_cvt_u32_f32 v51, v51
    v_lshlrev_b32 v51, 2, v51
    v_add_u32 v51, s22, v51
    v_sub_u32 v22, 2045, v14
    v_max_i32 v52, 0, v22
    v_cvt_f32_u32 v52, v52
    v_cvt_pk_bf16_f32 v52, v52, v52
    v_lshlrev_b32 v52, 16, v52
    v_cvt_u32_f32 v52, v52
    v_lshlrev_b32 v52, 2, v52
    v_add_u32 v52, s22, v52
    v_sub_u32 v23, 2044, v14
    v_max_i32 v53, 0, v23
    v_cvt_f32_u32 v53, v53
    v_cvt_pk_bf16_f32 v53, v53, v53
    v_lshlrev_b32 v53, 16, v53
    v_cvt_u32_f32 v53, v53
    v_lshlrev_b32 v53, 2, v53
    v_add_u32 v53, s22, v53
    v_sub_u32 v24, 2043, v14
    v_max_i32 v54, 0, v24
    v_cvt_f32_u32 v54, v54
    v_cvt_pk_bf16_f32 v54, v54, v54
    v_lshlrev_b32 v54, 16, v54
    v_cvt_u32_f32 v54, v54
    v_lshlrev_b32 v54, 2, v54
    v_add_u32 v54, s22, v54
    v_sub_u32 v25, 2042, v14
    v_max_i32 v55, 0, v25
    v_cvt_f32_u32 v55, v55
    v_cvt_pk_bf16_f32 v55, v55, v55
    v_lshlrev_b32 v55, 16, v55
    v_cvt_u32_f32 v55, v55
    v_lshlrev_b32 v55, 2, v55
    v_add_u32 v55, s22, v55
    v_sub_u32 v26, 2041, v14
    v_max_i32 v56, 0, v26
    v_cvt_f32_u32 v56, v56
    v_cvt_pk_bf16_f32 v56, v56, v56
    v_lshlrev_b32 v56, 16, v56
    v_cvt_u32_f32 v56, v56
    v_lshlrev_b32 v56, 2, v56
    v_add_u32 v56, s22, v56
    v_sub_u32 v27, 2040, v14
    v_max_i32 v57, 0, v27
    v_cvt_f32_u32 v57, v57
    v_cvt_pk_bf16_f32 v57, v57, v57
    v_lshlrev_b32 v57, 16, v57
    v_cvt_u32_f32 v57, v57
    v_lshlrev_b32 v57, 2, v57
    v_add_u32 v57, s22, v57
    ds_read_b32 v30, v50
    ds_read_b32 v31, v51
    ds_read_b32 v32, v52
    ds_read_b32 v33, v53
    ds_read_b32 v34, v54
    ds_read_b32 v35, v55
    ds_read_b32 v36, v56
    ds_read_b32 v37, v57
    s_waitcnt lgkmcnt(0)
    v_cmp_gt_i32 vcc, 0, v20
    s_nop 1
    v_cndmask_b32 v30, v30, 0, vcc
    v_cmp_gt_i32 vcc, 0, v21
    s_nop 1
    v_cndmask_b32 v31, v31, 0, vcc
    v_cmp_gt_i32 vcc, 0, v22
    s_nop 1
    v_cndmask_b32 v32, v32, 0, vcc
    v_cmp_gt_i32 vcc, 0, v23
    s_nop 1
    v_cndmask_b32 v33, v33, 0, vcc
    v_cmp_gt_i32 vcc, 0, v24
    s_nop 1
    v_cndmask_b32 v34, v34, 0, vcc
    v_cmp_gt_i32 vcc, 0, v25
    s_nop 1
    v_cndmask_b32 v35, v35, 0, vcc
    v_cmp_gt_i32 vcc, 0, v26
    s_nop 1
    v_cndmask_b32 v36, v36, 0, vcc
    v_cmp_gt_i32 vcc, 0, v27
    s_nop 1
    v_cndmask_b32 v37, v37, 0, vcc
    v_cvt_pk_bf16_f32 v40, v30, v31
    v_cvt_pk_bf16_f32 v41, v32, v33
    v_cvt_pk_bf16_f32 v42, v34, v35
    v_cvt_pk_bf16_f32 v43, v36, v37
    s_mov_b32 s23, 0
    buffer_store_dwordx4 v[40:43], v13, s[12:15], s23 offen
    s_nop 1
    v_sub_u32 v20, 1535, v14
    v_max_i32 v50, 0, v20
    v_cvt_f32_u32 v50, v50
    v_cvt_pk_bf16_f32 v50, v50, v50
    v_lshlrev_b32 v50, 16, v50
    v_cvt_u32_f32 v50, v50
    v_lshlrev_b32 v50, 2, v50
    v_add_u32 v50, s22, v50
    v_sub_u32 v21, 1534, v14
    v_max_i32 v51, 0, v21
    v_cvt_f32_u32 v51, v51
    v_cvt_pk_bf16_f32 v51, v51, v51
    v_lshlrev_b32 v51, 16, v51
    v_cvt_u32_f32 v51, v51
    v_lshlrev_b32 v51, 2, v51
    v_add_u32 v51, s22, v51
    v_sub_u32 v22, 1533, v14
    v_max_i32 v52, 0, v22
    v_cvt_f32_u32 v52, v52
    v_cvt_pk_bf16_f32 v52, v52, v52
    v_lshlrev_b32 v52, 16, v52
    v_cvt_u32_f32 v52, v52
    v_lshlrev_b32 v52, 2, v52
    v_add_u32 v52, s22, v52
    v_sub_u32 v23, 1532, v14
    v_max_i32 v53, 0, v23
    v_cvt_f32_u32 v53, v53
    v_cvt_pk_bf16_f32 v53, v53, v53
    v_lshlrev_b32 v53, 16, v53
    v_cvt_u32_f32 v53, v53
    v_lshlrev_b32 v53, 2, v53
    v_add_u32 v53, s22, v53
    v_sub_u32 v24, 1531, v14
    v_max_i32 v54, 0, v24
    v_cvt_f32_u32 v54, v54
    v_cvt_pk_bf16_f32 v54, v54, v54
    v_lshlrev_b32 v54, 16, v54
    v_cvt_u32_f32 v54, v54
    v_lshlrev_b32 v54, 2, v54
    v_add_u32 v54, s22, v54
    v_sub_u32 v25, 1530, v14
    v_max_i32 v55, 0, v25
    v_cvt_f32_u32 v55, v55
    v_cvt_pk_bf16_f32 v55, v55, v55
    v_lshlrev_b32 v55, 16, v55
    v_cvt_u32_f32 v55, v55
    v_lshlrev_b32 v55, 2, v55
    v_add_u32 v55, s22, v55
    v_sub_u32 v26, 1529, v14
    v_max_i32 v56, 0, v26
    v_cvt_f32_u32 v56, v56
    v_cvt_pk_bf16_f32 v56, v56, v56
    v_lshlrev_b32 v56, 16, v56
    v_cvt_u32_f32 v56, v56
    v_lshlrev_b32 v56, 2, v56
    v_add_u32 v56, s22, v56
    v_sub_u32 v27, 1528, v14
    v_max_i32 v57, 0, v27
    v_cvt_f32_u32 v57, v57
    v_cvt_pk_bf16_f32 v57, v57, v57
    v_lshlrev_b32 v57, 16, v57
    v_cvt_u32_f32 v57, v57
    v_lshlrev_b32 v57, 2, v57
    v_add_u32 v57, s22, v57
    ds_read_b32 v30, v50
    ds_read_b32 v31, v51
    ds_read_b32 v32, v52
    ds_read_b32 v33, v53
    ds_read_b32 v34, v54
    ds_read_b32 v35, v55
    ds_read_b32 v36, v56
    ds_read_b32 v37, v57
    s_waitcnt lgkmcnt(0)
    v_cmp_gt_i32 vcc, 0, v20
    s_nop 1
    v_cndmask_b32 v30, v30, 0, vcc
    v_cmp_gt_i32 vcc, 0, v21
    s_nop 1
    v_cndmask_b32 v31, v31, 0, vcc
    v_cmp_gt_i32 vcc, 0, v22
    s_nop 1
    v_cndmask_b32 v32, v32, 0, vcc
    v_cmp_gt_i32 vcc, 0, v23
    s_nop 1
    v_cndmask_b32 v33, v33, 0, vcc
    v_cmp_gt_i32 vcc, 0, v24
    s_nop 1
    v_cndmask_b32 v34, v34, 0, vcc
    v_cmp_gt_i32 vcc, 0, v25
    s_nop 1
    v_cndmask_b32 v35, v35, 0, vcc
    v_cmp_gt_i32 vcc, 0, v26
    s_nop 1
    v_cndmask_b32 v36, v36, 0, vcc
    v_cmp_gt_i32 vcc, 0, v27
    s_nop 1
    v_cndmask_b32 v37, v37, 0, vcc
    v_cvt_pk_bf16_f32 v40, v30, v31
    v_cvt_pk_bf16_f32 v41, v32, v33
    v_cvt_pk_bf16_f32 v42, v34, v35
    v_cvt_pk_bf16_f32 v43, v36, v37
    s_mov_b32 s23, 1024
    buffer_store_dwordx4 v[40:43], v13, s[12:15], s23 offen
    s_nop 1
    v_sub_u32 v20, 1023, v14
    v_max_i32 v50, 0, v20
    v_cvt_f32_u32 v50, v50
    v_cvt_pk_bf16_f32 v50, v50, v50
    v_lshlrev_b32 v50, 16, v50
    v_cvt_u32_f32 v50, v50
    v_lshlrev_b32 v50, 2, v50
    v_add_u32 v50, s22, v50
    v_sub_u32 v21, 1022, v14
    v_max_i32 v51, 0, v21
    v_cvt_f32_u32 v51, v51
    v_cvt_pk_bf16_f32 v51, v51, v51
    v_lshlrev_b32 v51, 16, v51
    v_cvt_u32_f32 v51, v51
    v_lshlrev_b32 v51, 2, v51
    v_add_u32 v51, s22, v51
    v_sub_u32 v22, 1021, v14
    v_max_i32 v52, 0, v22
    v_cvt_f32_u32 v52, v52
    v_cvt_pk_bf16_f32 v52, v52, v52
    v_lshlrev_b32 v52, 16, v52
    v_cvt_u32_f32 v52, v52
    v_lshlrev_b32 v52, 2, v52
    v_add_u32 v52, s22, v52
    v_sub_u32 v23, 1020, v14
    v_max_i32 v53, 0, v23
    v_cvt_f32_u32 v53, v53
    v_cvt_pk_bf16_f32 v53, v53, v53
    v_lshlrev_b32 v53, 16, v53
    v_cvt_u32_f32 v53, v53
    v_lshlrev_b32 v53, 2, v53
    v_add_u32 v53, s22, v53
    v_sub_u32 v24, 1019, v14
    v_max_i32 v54, 0, v24
    v_cvt_f32_u32 v54, v54
    v_cvt_pk_bf16_f32 v54, v54, v54
    v_lshlrev_b32 v54, 16, v54
    v_cvt_u32_f32 v54, v54
    v_lshlrev_b32 v54, 2, v54
    v_add_u32 v54, s22, v54
    v_sub_u32 v25, 1018, v14
    v_max_i32 v55, 0, v25
    v_cvt_f32_u32 v55, v55
    v_cvt_pk_bf16_f32 v55, v55, v55
    v_lshlrev_b32 v55, 16, v55
    v_cvt_u32_f32 v55, v55
    v_lshlrev_b32 v55, 2, v55
    v_add_u32 v55, s22, v55
    v_sub_u32 v26, 1017, v14
    v_max_i32 v56, 0, v26
    v_cvt_f32_u32 v56, v56
    v_cvt_pk_bf16_f32 v56, v56, v56
    v_lshlrev_b32 v56, 16, v56
    v_cvt_u32_f32 v56, v56
    v_lshlrev_b32 v56, 2, v56
    v_add_u32 v56, s22, v56
    v_sub_u32 v27, 1016, v14
    v_max_i32 v57, 0, v27
    v_cvt_f32_u32 v57, v57
    v_cvt_pk_bf16_f32 v57, v57, v57
    v_lshlrev_b32 v57, 16, v57
    v_cvt_u32_f32 v57, v57
    v_lshlrev_b32 v57, 2, v57
    v_add_u32 v57, s22, v57
    ds_read_b32 v30, v50
    ds_read_b32 v31, v51
    ds_read_b32 v32, v52
    ds_read_b32 v33, v53
    ds_read_b32 v34, v54
    ds_read_b32 v35, v55
    ds_read_b32 v36, v56
    ds_read_b32 v37, v57
    s_waitcnt lgkmcnt(0)
    v_cmp_gt_i32 vcc, 0, v20
    s_nop 1
    v_cndmask_b32 v30, v30, 0, vcc
    v_cmp_gt_i32 vcc, 0, v21
    s_nop 1
    v_cndmask_b32 v31, v31, 0, vcc
    v_cmp_gt_i32 vcc, 0, v22
    s_nop 1
    v_cndmask_b32 v32, v32, 0, vcc
    v_cmp_gt_i32 vcc, 0, v23
    s_nop 1
    v_cndmask_b32 v33, v33, 0, vcc
    v_cmp_gt_i32 vcc, 0, v24
    s_nop 1
    v_cndmask_b32 v34, v34, 0, vcc
    v_cmp_gt_i32 vcc, 0, v25
    s_nop 1
    v_cndmask_b32 v35, v35, 0, vcc
    v_cmp_gt_i32 vcc, 0, v26
    s_nop 1
    v_cndmask_b32 v36, v36, 0, vcc
    v_cmp_gt_i32 vcc, 0, v27
    s_nop 1
    v_cndmask_b32 v37, v37, 0, vcc
    v_cvt_pk_bf16_f32 v40, v30, v31
    v_cvt_pk_bf16_f32 v41, v32, v33
    v_cvt_pk_bf16_f32 v42, v34, v35
    v_cvt_pk_bf16_f32 v43, v36, v37
    s_mov_b32 s23, 2048
    buffer_store_dwordx4 v[40:43], v13, s[12:15], s23 offen
    s_nop 1
    v_sub_u32 v20, 511, v14
    v_max_i32 v50, 0, v20
    v_cvt_f32_u32 v50, v50
    v_cvt_pk_bf16_f32 v50, v50, v50
    v_lshlrev_b32 v50, 16, v50
    v_cvt_u32_f32 v50, v50
    v_lshlrev_b32 v50, 2, v50
    v_add_u32 v50, s22, v50
    v_sub_u32 v21, 510, v14
    v_max_i32 v51, 0, v21
    v_cvt_f32_u32 v51, v51
    v_cvt_pk_bf16_f32 v51, v51, v51
    v_lshlrev_b32 v51, 16, v51
    v_cvt_u32_f32 v51, v51
    v_lshlrev_b32 v51, 2, v51
    v_add_u32 v51, s22, v51
    v_sub_u32 v22, 509, v14
    v_max_i32 v52, 0, v22
    v_cvt_f32_u32 v52, v52
    v_cvt_pk_bf16_f32 v52, v52, v52
    v_lshlrev_b32 v52, 16, v52
    v_cvt_u32_f32 v52, v52
    v_lshlrev_b32 v52, 2, v52
    v_add_u32 v52, s22, v52
    v_sub_u32 v23, 508, v14
    v_max_i32 v53, 0, v23
    v_cvt_f32_u32 v53, v53
    v_cvt_pk_bf16_f32 v53, v53, v53
    v_lshlrev_b32 v53, 16, v53
    v_cvt_u32_f32 v53, v53
    v_lshlrev_b32 v53, 2, v53
    v_add_u32 v53, s22, v53
    v_sub_u32 v24, 507, v14
    v_max_i32 v54, 0, v24
    v_cvt_f32_u32 v54, v54
    v_cvt_pk_bf16_f32 v54, v54, v54
    v_lshlrev_b32 v54, 16, v54
    v_cvt_u32_f32 v54, v54
    v_lshlrev_b32 v54, 2, v54
    v_add_u32 v54, s22, v54
    v_sub_u32 v25, 506, v14
    v_max_i32 v55, 0, v25
    v_cvt_f32_u32 v55, v55
    v_cvt_pk_bf16_f32 v55, v55, v55
    v_lshlrev_b32 v55, 16, v55
    v_cvt_u32_f32 v55, v55
    v_lshlrev_b32 v55, 2, v55
    v_add_u32 v55, s22, v55
    v_sub_u32 v26, 505, v14
    v_max_i32 v56, 0, v26
    v_cvt_f32_u32 v56, v56
    v_cvt_pk_bf16_f32 v56, v56, v56
    v_lshlrev_b32 v56, 16, v56
    v_cvt_u32_f32 v56, v56
    v_lshlrev_b32 v56, 2, v56
    v_add_u32 v56, s22, v56
    v_sub_u32 v27, 504, v14
    v_max_i32 v57, 0, v27
    v_cvt_f32_u32 v57, v57
    v_cvt_pk_bf16_f32 v57, v57, v57
    v_lshlrev_b32 v57, 16, v57
    v_cvt_u32_f32 v57, v57
    v_lshlrev_b32 v57, 2, v57
    v_add_u32 v57, s22, v57
    ds_read_b32 v30, v50
    ds_read_b32 v31, v51
    ds_read_b32 v32, v52
    ds_read_b32 v33, v53
    ds_read_b32 v34, v54
    ds_read_b32 v35, v55
    ds_read_b32 v36, v56
    ds_read_b32 v37, v57
    s_waitcnt lgkmcnt(0)
    v_cmp_gt_i32 vcc, 0, v20
    s_nop 1
    v_cndmask_b32 v30, v30, 0, vcc
    v_cmp_gt_i32 vcc, 0, v21
    s_nop 1
    v_cndmask_b32 v31, v31, 0, vcc
    v_cmp_gt_i32 vcc, 0, v22
    s_nop 1
    v_cndmask_b32 v32, v32, 0, vcc
    v_cmp_gt_i32 vcc, 0, v23
    s_nop 1
    v_cndmask_b32 v33, v33, 0, vcc
    v_cmp_gt_i32 vcc, 0, v24
    s_nop 1
    v_cndmask_b32 v34, v34, 0, vcc
    v_cmp_gt_i32 vcc, 0, v25
    s_nop 1
    v_cndmask_b32 v35, v35, 0, vcc
    v_cmp_gt_i32 vcc, 0, v26
    s_nop 1
    v_cndmask_b32 v36, v36, 0, vcc
    v_cmp_gt_i32 vcc, 0, v27
    s_nop 1
    v_cndmask_b32 v37, v37, 0, vcc
    v_cvt_pk_bf16_f32 v40, v30, v31
    v_cvt_pk_bf16_f32 v41, v32, v33
    v_cvt_pk_bf16_f32 v42, v34, v35
    v_cvt_pk_bf16_f32 v43, v36, v37
    s_mov_b32 s23, 3072
    buffer_store_dwordx4 v[40:43], v13, s[12:15], s23 offen
    s_nop 1
    v_sub_u32 v20, -1, v14
    v_max_i32 v50, 0, v20
    v_cvt_f32_u32 v50, v50
    v_cvt_pk_bf16_f32 v50, v50, v50
    v_lshlrev_b32 v50, 16, v50
    v_cvt_u32_f32 v50, v50
    v_lshlrev_b32 v50, 2, v50
    v_add_u32 v50, s22, v50
    v_sub_u32 v21, -2, v14
    v_max_i32 v51, 0, v21
    v_cvt_f32_u32 v51, v51
    v_cvt_pk_bf16_f32 v51, v51, v51
    v_lshlrev_b32 v51, 16, v51
    v_cvt_u32_f32 v51, v51
    v_lshlrev_b32 v51, 2, v51
    v_add_u32 v51, s22, v51
    v_sub_u32 v22, -3, v14
    v_max_i32 v52, 0, v22
    v_cvt_f32_u32 v52, v52
    v_cvt_pk_bf16_f32 v52, v52, v52
    v_lshlrev_b32 v52, 16, v52
    v_cvt_u32_f32 v52, v52
    v_lshlrev_b32 v52, 2, v52
    v_add_u32 v52, s22, v52
    v_sub_u32 v23, -4, v14
    v_max_i32 v53, 0, v23
    v_cvt_f32_u32 v53, v53
    v_cvt_pk_bf16_f32 v53, v53, v53
    v_lshlrev_b32 v53, 16, v53
    v_cvt_u32_f32 v53, v53
    v_lshlrev_b32 v53, 2, v53
    v_add_u32 v53, s22, v53
    v_sub_u32 v24, -5, v14
    v_max_i32 v54, 0, v24
    v_cvt_f32_u32 v54, v54
    v_cvt_pk_bf16_f32 v54, v54, v54
    v_lshlrev_b32 v54, 16, v54
    v_cvt_u32_f32 v54, v54
    v_lshlrev_b32 v54, 2, v54
    v_add_u32 v54, s22, v54
    v_sub_u32 v25, -6, v14
    v_max_i32 v55, 0, v25
    v_cvt_f32_u32 v55, v55
    v_cvt_pk_bf16_f32 v55, v55, v55
    v_lshlrev_b32 v55, 16, v55
    v_cvt_u32_f32 v55, v55
    v_lshlrev_b32 v55, 2, v55
    v_add_u32 v55, s22, v55
    v_sub_u32 v26, -7, v14
    v_max_i32 v56, 0, v26
    v_cvt_f32_u32 v56, v56
    v_cvt_pk_bf16_f32 v56, v56, v56
    v_lshlrev_b32 v56, 16, v56
    v_cvt_u32_f32 v56, v56
    v_lshlrev_b32 v56, 2, v56
    v_add_u32 v56, s22, v56
    v_sub_u32 v27, -8, v14
    v_max_i32 v57, 0, v27
    v_cvt_f32_u32 v57, v57
    v_cvt_pk_bf16_f32 v57, v57, v57
    v_lshlrev_b32 v57, 16, v57
    v_cvt_u32_f32 v57, v57
    v_lshlrev_b32 v57, 2, v57
    v_add_u32 v57, s22, v57
    ds_read_b32 v30, v50
    ds_read_b32 v31, v51
    ds_read_b32 v32, v52
    ds_read_b32 v33, v53
    ds_read_b32 v34, v54
    ds_read_b32 v35, v55
    ds_read_b32 v36, v56
    ds_read_b32 v37, v57
    s_waitcnt lgkmcnt(0)
    v_cmp_gt_i32 vcc, 0, v20
    s_nop 1
    v_cndmask_b32 v30, v30, 0, vcc
    v_cmp_gt_i32 vcc, 0, v21
    s_nop 1
    v_cndmask_b32 v31, v31, 0, vcc
    v_cmp_gt_i32 vcc, 0, v22
    s_nop 1
    v_cndmask_b32 v32, v32, 0, vcc
    v_cmp_gt_i32 vcc, 0, v23
    s_nop 1
    v_cndmask_b32 v33, v33, 0, vcc
    v_cmp_gt_i32 vcc, 0, v24
    s_nop 1
    v_cndmask_b32 v34, v34, 0, vcc
    v_cmp_gt_i32 vcc, 0, v25
    s_nop 1
    v_cndmask_b32 v35, v35, 0, vcc
    v_cmp_gt_i32 vcc, 0, v26
    s_nop 1
    v_cndmask_b32 v36, v36, 0, vcc
    v_cmp_gt_i32 vcc, 0, v27
    s_nop 1
    v_cndmask_b32 v37, v37, 0, vcc
    v_cvt_pk_bf16_f32 v40, v30, v31
    v_cvt_pk_bf16_f32 v41, v32, v33
    v_cvt_pk_bf16_f32 v42, v34, v35
    v_cvt_pk_bf16_f32 v43, v36, v37
    s_mov_b32 s23, 4096
    buffer_store_dwordx4 v[40:43], v13, s[12:15], s23 offen
    s_nop 1
    s_endpgm
k1_tr:
    s_and_b32 s26, s2, 7
    s_lshr_b32 s2, s2, 3
    s_mov_b32 s8, s4
    s_and_b32 s9, s5, 0xffff
    s_mov_b32 s10, 0x400000
    s_mov_b32 s11, 0x00020000
    s_add_u32 s12, s6, 0x0
    s_addc_u32 s13, s7, 0
    s_and_b32 s13, s13, 0xffff
    s_mov_b32 s14, 0x400000
    s_mov_b32 s15, 0x00020000
    v_and_b32 v1, 63, v0
    v_lshrrev_b32 v2, 6, v0
    s_nop 1
    v_readfirstlane_b32 s20, v2
    s_nop 3
    v_lshrrev_b32 v3, 4, v1
    v_lshlrev_b32 v3, 11, v3
    v_and_b32 v4, 15, v1
    v_lshlrev_b32 v4, 4, v4
    v_add_u32 v3, v3, v4
    s_lshl_b32 s21, s2, 17
    s_lshl_b32 s22, s20, 15
    s_add_u32 s21, s21, s22
    s_lshl_b32 s23, s20, 12
    v_and_b32 v5, 15, v1
    v_lshrrev_b32 v5, 2, v5
    v_lshlrev_b32 v5, 8, v5
    v_and_b32 v6, 3, v1
    v_lshlrev_b32 v6, 3, v6
    v_lshrrev_b32 v7, 4, v1
    v_lshlrev_b32 v7, 5, v7
    v_add3_u32 v5, v5, v6, v7
    v_add_u32 v5, s23, v5
    v_and_b32 v6, 15, v1
    v_lshrrev_b32 v7, 4, v1
    v_lshl_add_u32 v6, v7, 4, v6
    v_lshlrev_b32 v6, 12, v6
    s_lshl_b32 s24, s2, 7
    s_lshl_b32 s25, s20, 5
    s_add_u32 s24, s24, s25
    v_add_u32 v6, s24, v6
k1_tr_loop:
    s_lshl_b32 s27, s26, 8
    s_add_u32 s27, s27, s21
    s_add_u32 s28, s23, 0
    s_mov_b32 m0, s28
    s_add_u32 s29, s27, 0
    s_nop 0
    buffer_load_dwordx4 v3, s[8:11], s29 offen lds
    s_add_u32 s28, s23, 1024
    s_mov_b32 m0, s28
    s_add_u32 s29, s27, 8192
    s_nop 0
    buffer_load_dwordx4 v3, s[8:11], s29 offen lds
    s_add_u32 s28, s23, 2048
    s_mov_b32 m0, s28
    s_add_u32 s29, s27, 16384
    s_nop 0
    buffer_load_dwordx4 v3, s[8:11], s29 offen lds
    s_add_u32 s28, s23, 3072
    s_mov_b32 m0, s28
    s_add_u32 s29, s27, 24576
    s_nop 0
    buffer_load_dwordx4 v3, s[8:11], s29 offen lds
    s_waitcnt vmcnt(0)
    s_lshl_b32 s30, s26, 19
    ds_read_b64_tr_b16 v[10:11], v5 offset:0
    ds_read_b64_tr_b16 v[12:13], v5 offset:1024
    ds_read_b64_tr_b16 v[14:15], v5 offset:2048
    ds_read_b64_tr_b16 v[16:17], v5 offset:3072
    ds_read_b64_tr_b16 v[18:19], v5 offset:128
    ds_read_b64_tr_b16 v[20:21], v5 offset:1152
    ds_read_b64_tr_b16 v[22:23], v5 offset:2176
    ds_read_b64_tr_b16 v[24:25], v5 offset:3200
    s_waitcnt lgkmcnt(0)
    s_add_u32 s31, s30, 0
    buffer_store_dwordx4 v[10:13], v6, s[12:15], s31 offen
    buffer_store_dwordx4 v[14:17], v6, s[12:15], s31 offen offset:16
    s_add_u32 s31, s30, 262144
    buffer_store_dwordx4 v[18:21], v6, s[12:15], s31 offen
    buffer_store_dwordx4 v[22:25], v6, s[12:15], s31 offen offset:16
    s_waitcnt vmcnt(0)
    s_endpgm
kx_end:
    s_endpgm
.text
.globl k2_kernel
.p2align 8
.type k2_kernel,@function
k2_kernel:
    s_load_dwordx2 s[4:5], s[0:1], 0
    s_load_dwordx2 s[6:7], s[0:1], 120
    s_waitcnt lgkmcnt(0)
    s_cmp_lt_u32 s2, 256
    s_cbranch_scc1 k2_main
    s_endpgm
k2_main:
    s_load_dwordx2 s[44:45], s[0:1], 64
    s_load_dwordx2 s[46:47], s[0:1], 96
    s_waitcnt lgkmcnt(0)
    s_mov_b32 s60, s44
    s_and_b32 s61, s45, 0xffff
    s_mov_b32 s62, 0x800
    s_mov_b32 s63, 0x00020000
    s_add_u32 s8, s6, 0x400000
    s_addc_u32 s9, s7, 0
    s_and_b32 s9, s9, 0xffff
    s_mov_b32 s10, 0x500000
    s_mov_b32 s11, 0x00020000
    s_add_u32 s12, s6, 0x0
    s_addc_u32 s13, s7, 0
    s_and_b32 s13, s13, 0xffff
    s_mov_b32 s14, 0x400000
    s_mov_b32 s15, 0x00020000
    s_add_u32 s16, s6, 0x2d00000
    s_addc_u32 s17, s7, 0
    s_and_b32 s17, s17, 0xffff
    s_mov_b32 s18, 0x400000
    s_mov_b32 s19, 0x00020000
    s_add_u32 s64, s6, 0x2400000
    s_addc_u32 s65, s7, 0
    s_and_b32 s65, s65, 0xffff
    s_mov_b32 s66, 0x400000
    s_mov_b32 s67, 0x00020000
    s_add_u32 s68, s6, 0x2800000
    s_addc_u32 s69, s7, 0
    s_and_b32 s69, s69, 0xffff
    s_mov_b32 s70, 0x40000
    s_mov_b32 s71, 0x00020000
    s_add_u32 s72, s6, 0x2000000
    s_addc_u32 s73, s7, 0
    s_and_b32 s73, s73, 0xffff
    s_mov_b32 s74, 0x400000
    s_mov_b32 s75, 0x00020000
    s_add_u32 s76, s6, 0x2900000
    s_addc_u32 s77, s7, 0
    s_and_b32 s77, s77, 0xffff
    s_mov_b32 s78, 0x400000
    s_mov_b32 s79, 0x00020000
    s_mov_b32 s80, s4
    s_and_b32 s81, s5, 0xffff
    s_mov_b32 s82, 0x400000
    s_mov_b32 s83, 0x00020000
    s_mov_b32 s84, s46
    s_and_b32 s85, s47, 0xffff
    s_mov_b32 s86, 0x800
    s_mov_b32 s87, 0x00020000
    s_add_u32 s88, s6, 0x3100000
    s_addc_u32 s89, s7, 0
    s_and_b32 s89, s89, 0xffff
    s_mov_b32 s90, 0x2000
    s_mov_b32 s91, 0x00020000
    s_mov_b32 s40, 0x3fb8aa3b
    s_mov_b32 s42, 0x358637bd
    v_and_b32 v1, 63, v0
    v_lshrrev_b32 v2, 6, v0
    s_nop 1
    v_readfirstlane_b32 s20, v2
    s_nop 3
    s_lshl_b32 s21, s2, 2
    s_add_u32 s21, s21, s20
    s_mul_i32 s22, s20, 30976
    s_lshr_b32 s36, s2, 3
    s_and_b32 s37, s2, 7
    v_lshlrev_b32 v3, 4, v1
    v_and_b32 v6, 31, v1
    v_lshrrev_b32 v7, 5, v1
    v_lshlrev_b32 v5, 2, v6
    s_mul_i32 s23, s21, 5120
    s_lshl_b32 s25, s21, 12
    s_mov_b32 s24, s22
    v_mov_b32 v12, v1
    s_mov_b32 s26, 0
k2_dma:
    s_mov_b32 m0, s24
    v_mul_u32_u24 v13, 205, v12
    v_lshrrev_b32 v13, 10, v13
    buffer_load_dwordx4 v3, s[8:11], s23 offen lds
    v_mul_u32_u24 v14, 5, v13
    v_sub_u32 v14, v12, v14
    v_min_u32 v14, 3, v14
    v_lshlrev_b32 v14, 4, v14
    v_lshl_add_u32 v14, v13, 6, v14
    s_add_u32 s27, s24, 25856
    s_mov_b32 m0, s27
    v_add_u32 v12, 64, v12
    buffer_load_dwordx4 v14, s[12:15], s25 offen lds
    s_add_u32 s24, s24, 1024
    s_add_u32 s23, s23, 1024
    s_add_u32 s26, s26, 1
    s_cmp_lt_u32 s26, 5
    s_cbranch_scc1 k2_dma
    s_lshl_b32 s26, s21, 1
    v_mov_b32 v4, s26
    buffer_load_ushort v4, v4, s[60:63], 0 offen
    s_lshl_b32 s23, s20, 7
    s_lshl_b32 s24, s37, 9
    s_add_u32 s23, s23, s24
    v_add_u32 v10, s23, v6
    v_lshlrev_b32 v10, 11, v10
    s_lshl_b32 s23, s36, 6
    v_add_u32 v10, s23, v10
    v_lshl_add_u32 v11, v7, 4, v10
    v_lshl_add_u32 v15, v7, 3, v10
    s_cmp_ge_u32 s37, 4
    s_cbranch_scc1 k2_noo1
    s_lshl_b32 s23, s36, 12
    s_lshl_b32 s24, s20, 10
    s_add_u32 s23, s23, s24
    buffer_load_dwordx4 v[128:131], v3, s[64:67], s23 offen
    s_add_u32 s23, s23, 131072
    buffer_load_dwordx4 v[132:135], v3, s[64:67], s23 offen
    s_add_u32 s23, s23, 131072
    buffer_load_dwordx4 v[136:139], v3, s[64:67], s23 offen
    s_add_u32 s23, s23, 131072
    buffer_load_dwordx4 v[140:143], v3, s[64:67], s23 offen
    s_add_u32 s23, s23, 131072
    buffer_load_dwordx4 v[144:147], v3, s[64:67], s23 offen
    s_add_u32 s23, s23, 131072
    buffer_load_dwordx4 v[148:151], v3, s[64:67], s23 offen
    s_add_u32 s23, s23, 131072
    buffer_load_dwordx4 v[152:155], v3, s[64:67], s23 offen
    s_add_u32 s23, s23, 131072
    buffer_load_dwordx4 v[156:159], v3, s[64:67], s23 offen
    s_add_u32 s23, s23, 131072
    buffer_load_dwordx4 v[160:163], v3, s[64:67], s23 offen
    s_add_u32 s23, s23, 131072
    buffer_load_dwordx4 v[164:167], v3, s[64:67], s23 offen
    s_add_u32 s23, s23, 131072
    buffer_load_dwordx4 v[168:171], v3, s[64:67], s23 offen
    s_add_u32 s23, s23, 131072
    buffer_load_dwordx4 v[172:175], v3, s[64:67], s23 offen
    s_add_u32 s23, s23, 131072
    buffer_load_dwordx4 v[176:179], v3, s[64:67], s23 offen
    s_add_u32 s23, s23, 131072
    buffer_load_dwordx4 v[180:183], v3, s[64:67], s23 offen
    s_add_u32 s23, s23, 131072
    buffer_load_dwordx4 v[184:187], v3, s[64:67], s23 offen
    s_add_u32 s23, s23, 131072
    buffer_load_dwordx4 v[188:191], v3, s[64:67], s23 offen
    s_add_u32 s23, s23, 131072
    v_lshl_add_u32 v12, v7, 16, v5
    s_lshl_b32 s23, s36, 7
    buffer_load_dword v192, v12, s[68:71], s23 offen
    s_add_u32 s23, s23, 4096
    buffer_load_dword v193, v12, s[68:71], s23 offen
    s_add_u32 s23, s23, 4096
    buffer_load_dword v194, v12, s[68:71], s23 offen
    s_add_u32 s23, s23, 4096
    buffer_load_dword v195, v12, s[68:71], s23 offen
    s_add_u32 s23, s23, 4096
    buffer_load_dword v196, v12, s[68:71], s23 offen
    s_add_u32 s23, s23, 4096
    buffer_load_dword v197, v12, s[68:71], s23 offen
    s_add_u32 s23, s23, 4096
    buffer_load_dword v198, v12, s[68:71], s23 offen
    s_add_u32 s23, s23, 4096
    buffer_load_dword v199, v12, s[68:71], s23 offen
    s_add_u32 s23, s23, 4096
    buffer_load_dword v200, v12, s[68:71], s23 offen
    s_add_u32 s23, s23, 4096
    buffer_load_dword v201, v12, s[68:71], s23 offen
    s_add_u32 s23, s23, 4096
    buffer_load_dword v202, v12, s[68:71], s23 offen
    s_add_u32 s23, s23, 4096
    buffer_load_dword v203, v12, s[68:71], s23 offen
    s_add_u32 s23, s23, 4096
    buffer_load_dword v204, v12, s[68:71], s23 offen
    s_add_u32 s23, s23, 4096
    buffer_load_dword v205, v12, s[68:71], s23 offen
    s_add_u32 s23, s23, 4096
    buffer_load_dword v206, v12, s[68:71], s23 offen
    s_add_u32 s23, s23, 4096
    buffer_load_dword v207, v12, s[68:71], s23 offen
    s_add_u32 s23, s23, 4096
    s_mov_b32 s38, 0
    buffer_load_dwordx4 v[208:211], v11, s[72:75], s38 offen
    buffer_load_dwordx4 v[212:215], v11, s[72:75], s38 offen offset:32
    s_mov_b32 s38, 65536
    buffer_load_dwordx4 v[216:219], v11, s[72:75], s38 offen
    buffer_load_dwordx4 v[220:223], v11, s[72:75], s38 offen offset:32
    s_mov_b32 s38, 131072
    buffer_load_dwordx4 v[224:227], v11, s[72:75], s38 offen
    buffer_load_dwordx4 v[228:231], v11, s[72:75], s38 offen offset:32
    s_mov_b32 s38, 196608
    buffer_load_dwordx4 v[232:235], v11, s[72:75], s38 offen
    buffer_load_dwordx4 v[236:239], v11, s[72:75], s38 offen offset:32
k2_noo1:
    buffer_load_dwordx4 v[24:27], v3, s[84:87], 0 offen
    buffer_load_dwordx4 v[28:31], v3, s[84:87], 0 offen offset:1024
    s_lshl_b32 s39, s21, 1
    s_lshl_b32 s23, s39, 11
    buffer_load_dwordx4 v[240:243], v3, s[80:83], s23 offen
    buffer_load_dwordx4 v[244:247], v3, s[80:83], s23 offen offset:1024
    buffer_load_dwordx4 v[248:251], v3, s[80:83], s23 offen offset:2048
    buffer_load_dwordx4 v[252:255], v3, s[80:83], s23 offen offset:3072
    v_mov_b32 v16, 0
    v_mov_b32 v17, 0
    v_mov_b32 v18, 0
    v_mov_b32 v19, 0
    v_add_u32 v12, s22, v3
    ds_write_b128 v12, v[16:19] offset:20736
    ds_write_b128 v12, v[16:19] offset:21760
    ds_write_b128 v12, v[16:19] offset:22784
    ds_write_b128 v12, v[16:19] offset:23808
    ds_write_b128 v12, v[16:19] offset:24832
    s_cmp_ge_u32 s37, 4
    s_cbranch_scc1 k2_w6
    s_waitcnt vmcnt(46)
    s_branch k2_wd
k2_w6:
    s_waitcnt vmcnt(6)
k2_wd:
    v_add_u32 v13, 2, v12
    v_add_u32 v14, 5184, v12
    s_mov_b32 s26, 0
k2_shf:
    ds_read_b128 v[64:67], v13 offset:0
    ds_read_b128 v[68:71], v13 offset:1024
    ds_read_b128 v[72:75], v13 offset:2048
    ds_read_b128 v[76:79], v13 offset:3072
    ds_read_b128 v[80:83], v13 offset:4096
    s_waitcnt lgkmcnt(0)
    ds_write_b128 v14, v[64:67] offset:0
    ds_write_b128 v14, v[68:71] offset:1024
    ds_write_b128 v14, v[72:75] offset:2048
    ds_write_b128 v14, v[76:79] offset:3072
    ds_write_b128 v14, v[80:83] offset:4096
    v_add_u32 v13, 2, v13
    v_add_u32 v14, 5184, v14
    s_add_u32 s26, s26, 1
    s_cmp_lt_u32 s26, 3
    s_cbranch_scc1 k2_shf
    s_waitcnt lgkmcnt(0)
    v_lshlrev_b32 v8, 3, v7
    v_sub_u32 v8, v8, v6
    v_add_u32 v8, 31, v8
    v_and_b32 v12, 3, v8
    v_sub_u32 v8, v8, v12
    v_lshlrev_b32 v8, 1, v8
    v_mul_u32_u24 v12, 5184, v12
    v_add_u32 v8, v8, v12
    v_add_u32 v8, s22, v8
    v_add_u32 v9, 1, v6
    v_mul_u32_u24 v9, 80, v9
    v_lshl_add_u32 v9, v7, 4, v9
    v_add_u32 v9, 20736, v9
    v_add_u32 v9, s22, v9
    v_add_u32 v8, 1856, v8
    v_add_u32 v9, 4800, v9
    v_mov_b32 v32, 0
    v_mov_b32 v33, 0
    v_mov_b32 v34, 0
    v_mov_b32 v35, 0
    v_mov_b32 v36, 0
    v_mov_b32 v37, 0
    v_mov_b32 v38, 0
    v_mov_b32 v39, 0
    v_mov_b32 v40, 0
    v_mov_b32 v41, 0
    v_mov_b32 v42, 0
    v_mov_b32 v43, 0
    v_mov_b32 v44, 0
    v_mov_b32 v45, 0
    v_mov_b32 v46, 0
    v_mov_b32 v47, 0
    v_mov_b32 v48, 0
    v_mov_b32 v49, 0
    v_mov_b32 v50, 0
    v_mov_b32 v51, 0
    v_mov_b32 v52, 0
    v_mov_b32 v53, 0
    v_mov_b32 v54, 0
    v_mov_b32 v55, 0
    v_mov_b32 v56, 0
    v_mov_b32 v57, 0
    v_mov_b32 v58, 0
    v_mov_b32 v59, 0
    v_mov_b32 v60, 0
    v_mov_b32 v61, 0
    v_mov_b32 v62, 0
    v_mov_b32 v63, 0
    ds_read_b64 v[64:65], v8 offset:2176
    ds_read_b64 v[66:67], v8 offset:2184
    ds_read_b64 v[68:69], v8 offset:2208
    ds_read_b64 v[70:71], v8 offset:2216
    ds_read_b64 v[72:73], v8 offset:128
    ds_read_b64 v[74:75], v8 offset:136
    ds_read_b64 v[76:77], v8 offset:160
    ds_read_b64 v[78:79], v8 offset:168
    ds_read_b128 v[80:83], v9 offset:240
    ds_read_b128 v[84:87], v9 offset:272
    ds_read_b128 v[88:91], v9 offset:2800
    ds_read_b128 v[92:95], v9 offset:2832
    s_mov_b32 s26, 0
k2_conv:
    ds_read_b64 v[96:97], v8 offset:2112
    ds_read_b64 v[98:99], v8 offset:2120
    ds_read_b64 v[100:101], v8 offset:2144
    ds_read_b64 v[102:103], v8 offset:2152
    ds_read_b64 v[104:105], v8 offset:64
    ds_read_b64 v[106:107], v8 offset:72
    ds_read_b64 v[108:109], v8 offset:96
    ds_read_b64 v[110:111], v8 offset:104
    ds_read_b128 v[112:115], v9 offset:160
    ds_read_b128 v[116:119], v9 offset:192
    ds_read_b128 v[120:123], v9 offset:2720
    ds_read_b128 v[124:127], v9 offset:2752
    s_waitcnt lgkmcnt(12)
    v_mfma_f32_32x32x16_bf16 v[32:47], v[64:67], v[80:83], v[32:47]
    v_mfma_f32_32x32x16_bf16 v[48:63], v[64:67], v[88:91], v[48:63]
    v_mfma_f32_32x32x16_bf16 v[48:63], v[72:75], v[80:83], v[48:63]
    v_mfma_f32_32x32x16_bf16 v[32:47], v[68:71], v[84:87], v[32:47]
    v_mfma_f32_32x32x16_bf16 v[48:63], v[68:71], v[92:95], v[48:63]
    v_mfma_f32_32x32x16_bf16 v[48:63], v[76:79], v[84:87], v[48:63]
    ds_read_b64 v[64:65], v8 offset:2048
    ds_read_b64 v[66:67], v8 offset:2056
    ds_read_b64 v[68:69], v8 offset:2080
    ds_read_b64 v[70:71], v8 offset:2088
    ds_read_b64 v[72:73], v8 offset:0
    ds_read_b64 v[74:75], v8 offset:8
    ds_read_b64 v[76:77], v8 offset:32
    ds_read_b64 v[78:79], v8 offset:40
    ds_read_b128 v[80:83], v9 offset:80
    ds_read_b128 v[84:87], v9 offset:112
    ds_read_b128 v[88:91], v9 offset:2640
    ds_read_b128 v[92:95], v9 offset:2672
    s_waitcnt lgkmcnt(12)
    v_mfma_f32_32x32x16_bf16 v[32:47], v[96:99], v[112:115], v[32:47]
    v_mfma_f32_32x32x16_bf16 v[48:63], v[96:99], v[120:123], v[48:63]
    v_mfma_f32_32x32x16_bf16 v[48:63], v[104:107], v[112:115], v[48:63]
    v_mfma_f32_32x32x16_bf16 v[32:47], v[100:103], v[116:119], v[32:47]
    v_mfma_f32_32x32x16_bf16 v[48:63], v[100:103], v[124:127], v[48:63]
    v_mfma_f32_32x32x16_bf16 v[48:63], v[108:111], v[116:119], v[48:63]
    v_subrev_u32 v8, 128, v8
    v_subrev_u32 v9, 160, v9
    s_add_u32 s26, s26, 1
    s_cmp_lt_u32 s26, 16
    s_cbranch_scc1 k2_conv
    s_waitcnt lgkmcnt(0)
    v_lshlrev_b32 v4, 16, v4
    v_lshlrev_b32 v10, 6, v6
    v_lshl_add_u32 v10, v7, 3, v10
    v_mul_u32_u24 v11, 80, v6
    v_lshl_add_u32 v11, v7, 3, v11
    v_add_u32 v11, s22, v11
    s_lshl_b32 s23, s21, 12
    v_add_u32 v10, s23, v10
    ds_read_b64 v[64:65], v11 offset:25856
    ds_read_b64 v[66:67], v11 offset:25872
    ds_read_b64 v[68:69], v11 offset:25888
    ds_read_b64 v[70:71], v11 offset:25904
    ds_read_b64 v[72:73], v11 offset:28416
    ds_read_b64 v[74:75], v11 offset:28432
    ds_read_b64 v[76:77], v11 offset:28448
    ds_read_b64 v[78:79], v11 offset:28464
    s_nop 7
    s_waitcnt lgkmcnt(0)
    s_mov_b32 s26, 0
k2_cep:
    v_lshlrev_b32 v100, 16, v64
    v_and_b32 v101, 0xffff0000, v64
    v_lshlrev_b32 v102, 16, v65
    v_and_b32 v103, 0xffff0000, v65
    v_mul_f32 v100, v100, v4
    v_mul_f32 v101, v101, v4
    v_mul_f32 v102, v102, v4
    v_mul_f32 v103, v103, v4
    v_cvt_pk_bf16_f32 v104, v100, v101
    v_cvt_pk_bf16_f32 v105, v102, v103
    v_cvt_pk_bf16_f32 v106, v32, v33
    v_cvt_pk_bf16_f32 v107, v34, v35
    v_lshlrev_b32 v100, 16, v104
    v_and_b32 v101, 0xffff0000, v104
    v_lshlrev_b32 v102, 16, v105
    v_and_b32 v103, 0xffff0000, v105
    v_lshlrev_b32 v108, 16, v106
    v_and_b32 v109, 0xffff0000, v106
    v_lshlrev_b32 v110, 16, v107
    v_and_b32 v111, 0xffff0000, v107
    v_add_f32 v100, v100, v108
    v_add_f32 v101, v101, v109
    v_add_f32 v102, v102, v110
    v_add_f32 v103, v103, v111
    v_cvt_pk_bf16_f32 v104, v100, v101
    v_cvt_pk_bf16_f32 v105, v102, v103
    buffer_store_dwordx2 v[104:105], v10, s[16:19], 0 offen
    v_mov_b32 v32, v36
    v_mov_b32 v33, v37
    v_mov_b32 v34, v38
    v_mov_b32 v35, v39
    v_mov_b32 v36, v40
    v_mov_b32 v37, v41
    v_mov_b32 v38, v42
    v_mov_b32 v39, v43
    v_mov_b32 v40, v44
    v_mov_b32 v41, v45
    v_mov_b32 v42, v46
    v_mov_b32 v43, v47
    v_mov_b32 v44, v48
    v_mov_b32 v45, v49
    v_mov_b32 v46, v50
    v_mov_b32 v47, v51
    v_mov_b32 v48, v52
    v_mov_b32 v49, v53
    v_mov_b32 v50, v54
    v_mov_b32 v51, v55
    v_mov_b32 v52, v56
    v_mov_b32 v53, v57
    v_mov_b32 v54, v58
    v_mov_b32 v55, v59
    v_mov_b32 v56, v60
    v_mov_b32 v57, v61
    v_mov_b32 v58, v62
    v_mov_b32 v59, v63
    v_mov_b32 v64, v66
    v_mov_b32 v65, v67
    v_mov_b32 v66, v68
    v_mov_b32 v67, v69
    v_mov_b32 v68, v70
    v_mov_b32 v69, v71
    v_mov_b32 v70, v72
    v_mov_b32 v71, v73
    v_mov_b32 v72, v74
    v_mov_b32 v73, v75
    v_mov_b32 v74, v76
    v_mov_b32 v75, v77
    v_mov_b32 v76, v78
    v_mov_b32 v77, v79
    s_add_u32 s26, s26, 1
    s_cmp_eq_u32 s26, 4
    s_cselect_b32 s27, 2048-48, 16
    v_add_u32 v10, s27, v10
    s_cmp_lt_u32 s26, 8
    s_cbranch_scc1 k2_cep
    s_waitcnt vmcnt(0)
    v_lshlrev_b32 v64, 16, v24
    v_and_b32 v65, 0xffff0000, v24
    v_lshlrev_b32 v66, 16, v25
    v_and_b32 v67, 0xffff0000, v25
    v_lshlrev_b32 v68, 16, v26
    v_and_b32 v69, 0xffff0000, v26
    v_lshlrev_b32 v70, 16, v27
    v_and_b32 v71, 0xffff0000, v27
    v_lshlrev_b32 v72, 16, v28
    v_and_b32 v73, 0xffff0000, v28
    v_lshlrev_b32 v74, 16, v29
    v_and_b32 v75, 0xffff0000, v29
    v_lshlrev_b32 v76, 16, v30
    v_and_b32 v77, 0xffff0000, v30
    v_lshlrev_b32 v78, 16, v31
    v_and_b32 v79, 0xffff0000, v31
    s_mov_b32 s26, 0
    s_lshl_b32 s23, s39, 2
    v_mov_b32 v42, s23
k2_gate:
    v_mov_b32 v40, 0
    v_lshlrev_b32 v32, 16, v240
    v_and_b32 v33, 0xffff0000, v240
    v_mul_f32 v32, v32, v64
    v_mul_f32 v33, v33, v65
    v_cvt_pk_bf16_f32 v32, v32, v33
    v_lshlrev_b32 v33, 16, v32
    v_and_b32 v34, 0xffff0000, v32
    v_add_f32 v40, v40, v33
    v_add_f32 v40, v40, v34
    v_lshlrev_b32 v32, 16, v241
    v_and_b32 v33, 0xffff0000, v241
    v_mul_f32 v32, v32, v66
    v_mul_f32 v33, v33, v67
    v_cvt_pk_bf16_f32 v32, v32, v33
    v_lshlrev_b32 v33, 16, v32
    v_and_b32 v34, 0xffff0000, v32
    v_add_f32 v40, v40, v33
    v_add_f32 v40, v40, v34
    v_lshlrev_b32 v32, 16, v242
    v_and_b32 v33, 0xffff0000, v242
    v_mul_f32 v32, v32, v68
    v_mul_f32 v33, v33, v69
    v_cvt_pk_bf16_f32 v32, v32, v33
    v_lshlrev_b32 v33, 16, v32
    v_and_b32 v34, 0xffff0000, v32
    v_add_f32 v40, v40, v33
    v_add_f32 v40, v40, v34
    v_lshlrev_b32 v32, 16, v243
    v_and_b32 v33, 0xffff0000, v243
    v_mul_f32 v32, v32, v70
    v_mul_f32 v33, v33, v71
    v_cvt_pk_bf16_f32 v32, v32, v33
    v_lshlrev_b32 v33, 16, v32
    v_and_b32 v34, 0xffff0000, v32
    v_add_f32 v40, v40, v33
    v_add_f32 v40, v40, v34
    v_lshlrev_b32 v32, 16, v244
    v_and_b32 v33, 0xffff0000, v244
    v_mul_f32 v32, v32, v72
    v_mul_f32 v33, v33, v73
    v_cvt_pk_bf16_f32 v32, v32, v33
    v_lshlrev_b32 v33, 16, v32
    v_and_b32 v34, 0xffff0000, v32
    v_add_f32 v40, v40, v33
    v_add_f32 v40, v40, v34
    v_lshlrev_b32 v32, 16, v245
    v_and_b32 v33, 0xffff0000, v245
    v_mul_f32 v32, v32, v74
    v_mul_f32 v33, v33, v75
    v_cvt_pk_bf16_f32 v32, v32, v33
    v_lshlrev_b32 v33, 16, v32
    v_and_b32 v34, 0xffff0000, v32
    v_add_f32 v40, v40, v33
    v_add_f32 v40, v40, v34
    v_lshlrev_b32 v32, 16, v246
    v_and_b32 v33, 0xffff0000, v246
    v_mul_f32 v32, v32, v76
    v_mul_f32 v33, v33, v77
    v_cvt_pk_bf16_f32 v32, v32, v33
    v_lshlrev_b32 v33, 16, v32
    v_and_b32 v34, 0xffff0000, v32
    v_add_f32 v40, v40, v33
    v_add_f32 v40, v40, v34
    v_lshlrev_b32 v32, 16, v247
    v_and_b32 v33, 0xffff0000, v247
    v_mul_f32 v32, v32, v78
    v_mul_f32 v33, v33, v79
    v_cvt_pk_bf16_f32 v32, v32, v33
    v_lshlrev_b32 v33, 16, v32
    v_and_b32 v34, 0xffff0000, v32
    v_add_f32 v40, v40, v33
    v_add_f32 v40, v40, v34
    s_nop 1
    v_add_f32_dpp v40, v40, v40 row_shr:1
    s_nop 1
    v_add_f32_dpp v40, v40, v40 row_shr:2
    s_nop 1
    v_add_f32_dpp v40, v40, v40 row_shr:4
    s_nop 1
    v_add_f32_dpp v40, v40, v40 row_shr:8
    s_nop 1
    v_add_f32_dpp v40, v40, v40 row_bcast:15 row_mask:0xa
    s_nop 1
    v_add_f32_dpp v40, v40, v40 row_bcast:31 row_mask:0xc
    s_nop 1
    v_cvt_pk_bf16_f32 v40, v40, v40
    v_lshlrev_b32 v40, 16, v40
    v_mul_f32 v40, s40, v40
    v_exp_f32 v40, -v40
    s_nop 0
    v_add_f32 v40, 1.0, v40
    v_rcp_f32 v40, v40
    s_nop 0
    v_cvt_pk_bf16_f32 v40, v40, v40
    v_lshlrev_b32 v40, 16, v40
    v_cmp_eq_u32 vcc, 63, v1
    s_and_saveexec_b64 s[24:25], vcc
    buffer_store_dword v40, v42, s[88:91], 0 offen
    s_mov_b64 exec, s[24:25]
    v_add_u32 v42, 4, v42
    v_mov_b32 v240, v248
    v_mov_b32 v241, v249
    v_mov_b32 v242, v250
    v_mov_b32 v243, v251
    v_mov_b32 v244, v252
    v_mov_b32 v245, v253
    v_mov_b32 v246, v254
    v_mov_b32 v247, v255
    s_add_u32 s26, s26, 1
    s_cmp_lt_u32 s26, 2
    s_cbranch_scc1 k2_gate
    s_cmp_ge_u32 s37, 4
    s_cbranch_scc1 k2_noo2
    v_add_f32 v128, v128, v132
    v_add_f32 v129, v129, v133
    v_add_f32 v130, v130, v134
    v_add_f32 v131, v131, v135
    v_add_f32 v128, v128, v136
    v_add_f32 v129, v129, v137
    v_add_f32 v130, v130, v138
    v_add_f32 v131, v131, v139
    v_add_f32 v128, v128, v140
    v_add_f32 v129, v129, v141
    v_add_f32 v130, v130, v142
    v_add_f32 v131, v131, v143
    v_add_f32 v128, v128, v144
    v_add_f32 v129, v129, v145
    v_add_f32 v130, v130, v146
    v_add_f32 v131, v131, v147
    v_add_f32 v128, v128, v148
    v_add_f32 v129, v129, v149
    v_add_f32 v130, v130, v150
    v_add_f32 v131, v131, v151
    v_add_f32 v128, v128, v152
    v_add_f32 v129, v129, v153
    v_add_f32 v130, v130, v154
    v_add_f32 v131, v131, v155
    v_add_f32 v128, v128, v156
    v_add_f32 v129, v129, v157
    v_add_f32 v130, v130, v158
    v_add_f32 v131, v131, v159
    v_add_f32 v128, v128, v160
    v_add_f32 v129, v129, v161
    v_add_f32 v130, v130, v162
    v_add_f32 v131, v131, v163
    v_add_f32 v128, v128, v164
    v_add_f32 v129, v129, v165
    v_add_f32 v130, v130, v166
    v_add_f32 v131, v131, v167
    v_add_f32 v128, v128, v168
    v_add_f32 v129, v129, v169
    v_add_f32 v130, v130, v170
    v_add_f32 v131, v131, v171
    v_add_f32 v128, v128, v172
    v_add_f32 v129, v129, v173
    v_add_f32 v130, v130, v174
    v_add_f32 v131, v131, v175
    v_add_f32 v128, v128, v176
    v_add_f32 v129, v129, v177
    v_add_f32 v130, v130, v178
    v_add_f32 v131, v131, v179
    v_add_f32 v128, v128, v180
    v_add_f32 v129, v129, v181
    v_add_f32 v130, v130, v182
    v_add_f32 v131, v131, v183
    v_add_f32 v128, v128, v184
    v_add_f32 v129, v129, v185
    v_add_f32 v130, v130, v186
    v_add_f32 v131, v131, v187
    v_add_f32 v128, v128, v188
    v_add_f32 v129, v129, v189
    v_add_f32 v130, v130, v190
    v_add_f32 v131, v131, v191
    v_add_f32 v192, v192, v193
    v_add_f32 v192, v192, v194
    v_add_f32 v192, v192, v195
    v_add_f32 v192, v192, v196
    v_add_f32 v192, v192, v197
    v_add_f32 v192, v192, v198
    v_add_f32 v192, v192, v199
    v_add_f32 v192, v192, v200
    v_add_f32 v192, v192, v201
    v_add_f32 v192, v192, v202
    v_add_f32 v192, v192, v203
    v_add_f32 v192, v192, v204
    v_add_f32 v192, v192, v205
    v_add_f32 v192, v192, v206
    v_add_f32 v192, v192, v207
    s_lshl_b32 s23, s20, 10
    s_add_u32 s23, s23, 123904
    v_add_u32 v12, s23, v3
    ds_write_b128 v12, v[128:131]
    v_lshlrev_b32 v12, 2, v1
    v_add_u32 v12, 123904, v12
    ds_write_b32 v12, v192 offset:4096
    s_waitcnt lgkmcnt(0)
    s_barrier
    v_lshl_add_u32 v12, v7, 10, v5
    v_add_u32 v12, 123904, v12
    v_lshlrev_b32 v13, 5, v7
    v_add_u32 v13, 123904, v13
    ds_read_b32 v64, v12 offset:0
    ds_read_b32 v65, v12 offset:128
    ds_read_b32 v66, v12 offset:256
    ds_read_b32 v67, v12 offset:384
    ds_read_b32 v68, v12 offset:512
    ds_read_b32 v69, v12 offset:640
    ds_read_b32 v70, v12 offset:768
    ds_read_b32 v71, v12 offset:896
    ds_read_b32 v72, v12 offset:2048
    ds_read_b32 v73, v12 offset:2176
    ds_read_b32 v74, v12 offset:2304
    ds_read_b32 v75, v12 offset:2432
    ds_read_b32 v76, v12 offset:2560
    ds_read_b32 v77, v12 offset:2688
    ds_read_b32 v78, v12 offset:2816
    ds_read_b32 v79, v12 offset:2944
    ds_read_b32 v96, v13 offset:4096
    ds_read_b32 v97, v13 offset:4224
    ds_read_b32 v98, v13 offset:4100
    ds_read_b32 v99, v13 offset:4228
    ds_read_b32 v100, v13 offset:4104
    ds_read_b32 v101, v13 offset:4232
    ds_read_b32 v102, v13 offset:4108
    ds_read_b32 v103, v13 offset:4236
    ds_read_b32 v104, v13 offset:4112
    ds_read_b32 v105, v13 offset:4240
    ds_read_b32 v106, v13 offset:4116
    ds_read_b32 v107, v13 offset:4244
    ds_read_b32 v108, v13 offset:4120
    ds_read_b32 v109, v13 offset:4248
    ds_read_b32 v110, v13 offset:4124
    ds_read_b32 v111, v13 offset:4252
    ds_read_b32 v112, v13 offset:4160
    ds_read_b32 v113, v13 offset:4288
    ds_read_b32 v114, v13 offset:4164
    ds_read_b32 v115, v13 offset:4292
    ds_read_b32 v116, v13 offset:4168
    ds_read_b32 v117, v13 offset:4296
    ds_read_b32 v118, v13 offset:4172
    ds_read_b32 v119, v13 offset:4300
    ds_read_b32 v120, v13 offset:4176
    ds_read_b32 v121, v13 offset:4304
    ds_read_b32 v122, v13 offset:4180
    ds_read_b32 v123, v13 offset:4308
    ds_read_b32 v124, v13 offset:4184
    ds_read_b32 v125, v13 offset:4312
    ds_read_b32 v126, v13 offset:4188
    ds_read_b32 v127, v13 offset:4316
    s_waitcnt lgkmcnt(0)
    v_add_f32 v96, v96, v97
    v_add_f32 v98, v98, v99
    v_add_f32 v100, v100, v101
    v_add_f32 v102, v102, v103
    v_add_f32 v104, v104, v105
    v_add_f32 v106, v106, v107
    v_add_f32 v108, v108, v109
    v_add_f32 v110, v110, v111
    v_add_f32 v112, v112, v113
    v_add_f32 v114, v114, v115
    v_add_f32 v116, v116, v117
    v_add_f32 v118, v118, v119
    v_add_f32 v120, v120, v121
    v_add_f32 v122, v122, v123
    v_add_f32 v124, v124, v125
    v_add_f32 v126, v126, v127
    v_cvt_pk_bf16_f32 v20, v64, v65
    v_cvt_pk_bf16_f32 v28, v96, v98
    v_cvt_pk_bf16_f32 v21, v66, v67
    v_cvt_pk_bf16_f32 v29, v100, v102
    v_cvt_pk_bf16_f32 v22, v68, v69
    v_cvt_pk_bf16_f32 v30, v104, v106
    v_cvt_pk_bf16_f32 v23, v70, v71
    v_cvt_pk_bf16_f32 v31, v108, v110
    v_cvt_pk_bf16_f32 v24, v72, v73
    v_cvt_pk_bf16_f32 v32, v112, v114
    v_cvt_pk_bf16_f32 v25, v74, v75
    v_cvt_pk_bf16_f32 v33, v116, v118
    v_cvt_pk_bf16_f32 v26, v76, v77
    v_cvt_pk_bf16_f32 v34, v120, v122
    v_cvt_pk_bf16_f32 v27, v78, v79
    v_cvt_pk_bf16_f32 v35, v124, v126
    s_mov_b32 s26, 0
    s_mov_b32 s38, 0
k2_otile:
    v_mov_b32 v64, 0
    v_mov_b32 v65, 0
    v_mov_b32 v66, 0
    v_mov_b32 v67, 0
    v_mov_b32 v68, 0
    v_mov_b32 v69, 0
    v_mov_b32 v70, 0
    v_mov_b32 v71, 0
    v_mov_b32 v72, 0
    v_mov_b32 v73, 0
    v_mov_b32 v74, 0
    v_mov_b32 v75, 0
    v_mov_b32 v76, 0
    v_mov_b32 v77, 0
    v_mov_b32 v78, 0
    v_mov_b32 v79, 0
    v_mov_b32 v80, 0
    v_mov_b32 v81, 0
    v_mov_b32 v82, 0
    v_mov_b32 v83, 0
    v_mov_b32 v84, 0
    v_mov_b32 v85, 0
    v_mov_b32 v86, 0
    v_mov_b32 v87, 0
    v_mov_b32 v88, 0
    v_mov_b32 v89, 0
    v_mov_b32 v90, 0
    v_mov_b32 v91, 0
    v_mov_b32 v92, 0
    v_mov_b32 v93, 0
    v_mov_b32 v94, 0
    v_mov_b32 v95, 0
    s_nop 1
    v_mfma_f32_32x32x16_bf16 v[64:79], v[20:23], v[208:211], v[64:79]
    v_mfma_f32_32x32x16_bf16 v[80:95], v[28:31], v[208:211], v[80:95]
    v_mfma_f32_32x32x16_bf16 v[64:79], v[24:27], v[212:215], v[64:79]
    v_mfma_f32_32x32x16_bf16 v[80:95], v[32:35], v[212:215], v[80:95]
    s_nop 7
    v_mov_b32 v208, v216
    v_mov_b32 v209, v217
    v_mov_b32 v210, v218
    v_mov_b32 v211, v219
    v_mov_b32 v212, v220
    v_mov_b32 v213, v221
    v_mov_b32 v214, v222
    v_mov_b32 v215, v223
    v_mov_b32 v216, v224
    v_mov_b32 v217, v225
    v_mov_b32 v218, v226
    v_mov_b32 v219, v227
    v_mov_b32 v220, v228
    v_mov_b32 v221, v229
    v_mov_b32 v222, v230
    v_mov_b32 v223, v231
    v_mov_b32 v224, v232
    v_mov_b32 v225, v233
    v_mov_b32 v226, v234
    v_mov_b32 v227, v235
    v_mov_b32 v228, v236
    v_mov_b32 v229, v237
    v_mov_b32 v230, v238
    v_mov_b32 v231, v239
    v_cvt_pk_bf16_f32 v48, v80, v80
    v_lshlrev_b32 v48, 16, v48
    v_add_f32 v48, s42, v48
    v_cvt_pk_bf16_f32 v48, v48, v48
    v_lshlrev_b32 v48, 16, v48
    v_rcp_f32 v48, v48
    v_cvt_pk_bf16_f32 v50, v64, v65
    v_cvt_pk_bf16_f32 v51, v66, v67
    v_lshlrev_b32 v52, 16, v50
    v_and_b32 v53, 0xffff0000, v50
    v_lshlrev_b32 v54, 16, v51
    v_and_b32 v55, 0xffff0000, v51
    v_mul_f32 v52, v52, v48
    v_mul_f32 v53, v53, v48
    v_mul_f32 v54, v54, v48
    v_mul_f32 v55, v55, v48
    v_cvt_pk_bf16_f32 v56, v52, v53
    v_cvt_pk_bf16_f32 v57, v54, v55
    buffer_store_dwordx2 v[56:57], v15, s[76:79], s38 offen offset:0
    v_cvt_pk_bf16_f32 v50, v68, v69
    v_cvt_pk_bf16_f32 v51, v70, v71
    v_lshlrev_b32 v52, 16, v50
    v_and_b32 v53, 0xffff0000, v50
    v_lshlrev_b32 v54, 16, v51
    v_and_b32 v55, 0xffff0000, v51
    v_mul_f32 v52, v52, v48
    v_mul_f32 v53, v53, v48
    v_mul_f32 v54, v54, v48
    v_mul_f32 v55, v55, v48
    v_cvt_pk_bf16_f32 v58, v52, v53
    v_cvt_pk_bf16_f32 v59, v54, v55
    buffer_store_dwordx2 v[58:59], v15, s[76:79], s38 offen offset:16
    v_cvt_pk_bf16_f32 v50, v72, v73
    v_cvt_pk_bf16_f32 v51, v74, v75
    v_lshlrev_b32 v52, 16, v50
    v_and_b32 v53, 0xffff0000, v50
    v_lshlrev_b32 v54, 16, v51
    v_and_b32 v55, 0xffff0000, v51
    v_mul_f32 v52, v52, v48
    v_mul_f32 v53, v53, v48
    v_mul_f32 v54, v54, v48
    v_mul_f32 v55, v55, v48
    v_cvt_pk_bf16_f32 v56, v52, v53
    v_cvt_pk_bf16_f32 v57, v54, v55
    buffer_store_dwordx2 v[56:57], v15, s[76:79], s38 offen offset:32
    v_cvt_pk_bf16_f32 v50, v76, v77
    v_cvt_pk_bf16_f32 v51, v78, v79
    v_lshlrev_b32 v52, 16, v50
    v_and_b32 v53, 0xffff0000, v50
    v_lshlrev_b32 v54, 16, v51
    v_and_b32 v55, 0xffff0000, v51
    v_mul_f32 v52, v52, v48
    v_mul_f32 v53, v53, v48
    v_mul_f32 v54, v54, v48
    v_mul_f32 v55, v55, v48
    v_cvt_pk_bf16_f32 v58, v52, v53
    v_cvt_pk_bf16_f32 v59, v54, v55
    buffer_store_dwordx2 v[58:59], v15, s[76:79], s38 offen offset:48
    s_add_u32 s38, s38, 0x10000
    s_add_u32 s26, s26, 1
    s_cmp_lt_u32 s26, 4
    s_cbranch_scc1 k2_otile
k2_noo2:
    s_waitcnt lgkmcnt(0)
    s_endpgm
.text
.globl k3_kernel
.p2align 8
.type k3_kernel,@function
k3_kernel:
    s_load_dwordx2 s[4:5], s[0:1], 0
    s_load_dwordx2 s[6:7], s[0:1], 120
    s_waitcnt lgkmcnt(0)
    s_cmp_lt_u32 s2, 256
    s_cbranch_scc1 k3_fin
    s_endpgm
k3_fin:
    s_load_dwordx2 s[44:45], s[0:1], 88
    s_load_dwordx2 s[46:47], s[0:1], 104
    s_waitcnt lgkmcnt(0)
    s_add_u32 s8, s6, 0x2900000
    s_addc_u32 s9, s7, 0
    s_and_b32 s9, s9, 0xffff
    s_mov_b32 s10, 0x400000
    s_mov_b32 s11, 0x00020000
    s_mov_b32 s12, s44
    s_and_b32 s13, s45, 0xffff
    s_mov_b32 s14, 0x200000
    s_mov_b32 s15, 0x00020000
    s_mov_b32 s16, s46
    s_and_b32 s17, s47, 0xffff
    s_mov_b32 s18, 0x400000
    s_mov_b32 s19, 0x00020000
    s_add_u32 s60, s6, 0x2d00000
    s_addc_u32 s61, s7, 0
    s_and_b32 s61, s61, 0xffff
    s_mov_b32 s62, 0x400000
    s_mov_b32 s63, 0x00020000
    s_add_u32 s64, s6, 0x3100000
    s_addc_u32 s65, s7, 0
    s_and_b32 s65, s65, 0xffff
    s_mov_b32 s66, 0x2000
    s_mov_b32 s67, 0x00020000
    v_and_b32 v1, 63, v0
    v_lshrrev_b32 v2, 6, v0
    s_nop 1
    v_readfirstlane_b32 s20, v2
    s_nop 3
    s_lshr_b32 s21, s2, 4
    s_and_b32 s22, s2, 15
    s_lshr_b32 s23, s20, 1
    s_and_b32 s24, s20, 1
    v_lshrrev_b32 v3, 4, v1
    v_and_b32 v4, 15, v1
    v_lshlrev_b32 v4, 4, v4
    v_lshl_add_u32 v3, v3, 12, v4
    s_lshl_b32 s25, s22, 18
    s_lshl_b32 s26, s21, 8
    s_add_u32 s25, s25, s26
    s_lshl_b32 s26, s20, 16
    s_add_u32 s25, s25, s26
    s_lshl_b32 s26, s20, 12
    s_add_u32 s27, s26, 73728
    s_mov_b32 m0, s27
    s_add_u32 s28, s25, 0
    s_nop 0
    buffer_load_dwordx4 v3, s[60:63], s28 offen lds
    s_add_u32 s27, s26, 74752
    s_mov_b32 m0, s27
    s_add_u32 s28, s25, 16384
    s_nop 0
    buffer_load_dwordx4 v3, s[60:63], s28 offen lds
    s_add_u32 s27, s26, 75776
    s_mov_b32 m0, s27
    s_add_u32 s28, s25, 32768
    s_nop 0
    buffer_load_dwordx4 v3, s[60:63], s28 offen lds
    s_add_u32 s27, s26, 76800
    s_mov_b32 m0, s27
    s_add_u32 s28, s25, 49152
    s_nop 0
    buffer_load_dwordx4 v3, s[60:63], s28 offen lds
    v_lshrrev_b32 v3, 3, v1
    v_and_b32 v4, 7, v1
    v_lshrrev_b32 v5, 1, v3
    v_xor_b32 v4, v4, v5
    v_lshlrev_b32 v4, 4, v4
    v_lshl_add_u32 v2, v3, 11, v4
    v_xor_b32 v3, 64, v2
    v_lshrrev_b32 v5, 3, v1
    v_and_b32 v4, 7, v1
    v_lshrrev_b32 v6, 1, v5
    v_and_b32 v6, 1, v6
    v_lshlrev_b32 v6, 2, v6
    v_xor_b32 v4, v4, v6
    v_lshlrev_b32 v4, 4, v4
    v_lshl_add_u32 v4, v5, 11, v4
    s_lshl_b32 s25, s22, 7
    v_add_u32 v4, s25, v4
    v_and_b32 v7, 31, v1
    v_lshrrev_b32 v8, 5, v1
    v_lshrrev_b32 v9, 1, v7
    v_and_b32 v9, 7, v9
    s_lshl_b32 s26, s23, 13
    v_add_u32 v10, 0, v8
    v_xor_b32 v10, v10, v9
    v_lshlrev_b32 v10, 4, v10
    v_lshl_add_u32 v10, v7, 7, v10
    v_add_u32 v12, s26, v10
    v_add_u32 v10, 2, v8
    v_xor_b32 v10, v10, v9
    v_lshlrev_b32 v10, 4, v10
    v_lshl_add_u32 v10, v7, 7, v10
    v_add_u32 v13, s26, v10
    v_add_u32 v10, 4, v8
    v_xor_b32 v10, v10, v9
    v_lshlrev_b32 v10, 4, v10
    v_lshl_add_u32 v10, v7, 7, v10
    v_add_u32 v14, s26, v10
    v_add_u32 v10, 6, v8
    v_xor_b32 v10, v10, v9
    v_lshlrev_b32 v10, 4, v10
    v_lshl_add_u32 v10, v7, 7, v10
    v_add_u32 v15, s26, v10
    v_and_b32 v10, 15, v1
    v_lshrrev_b32 v10, 2, v10
    v_lshl_add_u32 v11, v8, 3, v10
    v_lshlrev_b32 v11, 7, v11
    v_lshrrev_b32 v10, 1, v10
    v_lshlrev_b32 v10, 6, v10
    v_lshrrev_b32 v16, 4, v1
    v_and_b32 v16, 1, v16
    v_lshlrev_b32 v16, 5, v16
    v_and_b32 v17, 3, v1
    v_lshl_add_u32 v16, v17, 3, v16
    v_mov_b32 v18, v16
    s_lshl_b32 s26, s24, 6
    v_add_u32 v16, s26, v16
    v_xor_b32 v16, v16, v10
    v_add_u32 v16, v16, v11
    v_add_u32 v16, 16384, v16
    s_lshl_b32 s27, s21, 18
    s_lshl_b32 s28, s20, 16
    s_add_u32 s27, s27, s28
    s_lshl_b32 s28, s20, 15
    s_mov_b32 s29, 0
    s_mov_b32 s30, 0
    v_mov_b32 v64, 0
    v_mov_b32 v65, 0
    v_mov_b32 v66, 0
    v_mov_b32 v67, 0
    v_mov_b32 v68, 0
    v_mov_b32 v69, 0
    v_mov_b32 v70, 0
    v_mov_b32 v71, 0
    v_mov_b32 v72, 0
    v_mov_b32 v73, 0
    v_mov_b32 v74, 0
    v_mov_b32 v75, 0
    v_mov_b32 v76, 0
    v_mov_b32 v77, 0
    v_mov_b32 v78, 0
    v_mov_b32 v79, 0
    v_mov_b32 v80, 0
    v_mov_b32 v81, 0
    v_mov_b32 v82, 0
    v_mov_b32 v83, 0
    v_mov_b32 v84, 0
    v_mov_b32 v85, 0
    v_mov_b32 v86, 0
    v_mov_b32 v87, 0
    v_mov_b32 v88, 0
    v_mov_b32 v89, 0
    v_mov_b32 v90, 0
    v_mov_b32 v91, 0
    v_mov_b32 v92, 0
    v_mov_b32 v93, 0
    v_mov_b32 v94, 0
    v_mov_b32 v95, 0
    s_lshl_b32 s31, s29, 7
    s_add_u32 s31, s31, s27
    s_lshl_b32 s32, s20, 12
    s_add_u32 s32, s32, s30
    s_add_u32 s33, s32, 0
    s_mov_b32 m0, s33
    s_add_u32 s34, s31, 0
    s_nop 0
    buffer_load_dwordx4 v2, s[8:11], s34 offen lds
    s_add_u32 s33, s32, 1024
    s_mov_b32 m0, s33
    s_add_u32 s34, s31, 16384
    s_nop 0
    buffer_load_dwordx4 v3, s[8:11], s34 offen lds
    s_add_u32 s33, s32, 2048
    s_mov_b32 m0, s33
    s_add_u32 s34, s31, 32768
    s_nop 0
    buffer_load_dwordx4 v2, s[8:11], s34 offen lds
    s_add_u32 s33, s32, 3072
    s_mov_b32 m0, s33
    s_add_u32 s34, s31, 49152
    s_nop 0
    buffer_load_dwordx4 v3, s[8:11], s34 offen lds
    s_lshl_b32 s31, s29, 17
    s_add_u32 s31, s31, s28
    s_lshl_b32 s32, s20, 11
    s_add_u32 s32, s32, s30
    s_add_u32 s32, s32, 16384
    s_add_u32 s33, s32, 0
    s_mov_b32 m0, s33
    s_add_u32 s34, s31, 0
    s_nop 0
    buffer_load_dwordx4 v4, s[12:15], s34 offen lds
    s_add_u32 s33, s32, 1024
    s_mov_b32 m0, s33
    s_add_u32 s34, s31, 16384
    s_nop 0
    buffer_load_dwordx4 v4, s[12:15], s34 offen lds
    s_add_u32 s29, s29, 1
    s_add_u32 s30, s30, 24576
    s_cmp_ge_u32 s30, 73728
    s_cselect_b32 s30, 0, s30
    s_lshl_b32 s31, s29, 7
    s_add_u32 s31, s31, s27
    s_lshl_b32 s32, s20, 12
    s_add_u32 s32, s32, s30
    s_add_u32 s33, s32, 0
    s_mov_b32 m0, s33
    s_add_u32 s34, s31, 0
    s_nop 0
    buffer_load_dwordx4 v2, s[8:11], s34 offen lds
    s_add_u32 s33, s32, 1024
    s_mov_b32 m0, s33
    s_add_u32 s34, s31, 16384
    s_nop 0
    buffer_load_dwordx4 v3, s[8:11], s34 offen lds
    s_add_u32 s33, s32, 2048
    s_mov_b32 m0, s33
    s_add_u32 s34, s31, 32768
    s_nop 0
    buffer_load_dwordx4 v2, s[8:11], s34 offen lds
    s_add_u32 s33, s32, 3072
    s_mov_b32 m0, s33
    s_add_u32 s34, s31, 49152
    s_nop 0
    buffer_load_dwordx4 v3, s[8:11], s34 offen lds
    s_lshl_b32 s31, s29, 17
    s_add_u32 s31, s31, s28
    s_lshl_b32 s32, s20, 11
    s_add_u32 s32, s32, s30
    s_add_u32 s32, s32, 16384
    s_add_u32 s33, s32, 0
    s_mov_b32 m0, s33
    s_add_u32 s34, s31, 0
    s_nop 0
    buffer_load_dwordx4 v4, s[12:15], s34 offen lds
    s_add_u32 s33, s32, 1024
    s_mov_b32 m0, s33
    s_add_u32 s34, s31, 16384
    s_nop 0
    buffer_load_dwordx4 v4, s[12:15], s34 offen lds
    s_add_u32 s29, s29, 1
    s_add_u32 s30, s30, 24576
    s_cmp_ge_u32 s30, 73728
    s_cselect_b32 s30, 0, s30
    s_mov_b32 s35, 0
    s_mov_b32 s36, 0
k3_fin_loop:
    s_cmp_lt_u32 s35, 15
    s_cbranch_scc1 k3_fin_w6
    s_waitcnt vmcnt(0)
    s_branch k3_fin_wd
k3_fin_w6:
    s_waitcnt vmcnt(6)
k3_fin_wd:
    s_barrier
    s_cmp_lt_u32 s29, 16
    s_cbranch_scc0 k3_fin_nodma
    s_lshl_b32 s31, s29, 7
    s_add_u32 s31, s31, s27
    s_lshl_b32 s32, s20, 12
    s_add_u32 s32, s32, s30
    s_add_u32 s33, s32, 0
    s_mov_b32 m0, s33
    s_add_u32 s34, s31, 0
    s_nop 0
    buffer_load_dwordx4 v2, s[8:11], s34 offen lds
    s_add_u32 s33, s32, 1024
    s_mov_b32 m0, s33
    s_add_u32 s34, s31, 16384
    s_nop 0
    buffer_load_dwordx4 v3, s[8:11], s34 offen lds
    s_add_u32 s33, s32, 2048
    s_mov_b32 m0, s33
    s_add_u32 s34, s31, 32768
    s_nop 0
    buffer_load_dwordx4 v2, s[8:11], s34 offen lds
    s_add_u32 s33, s32, 3072
    s_mov_b32 m0, s33
    s_add_u32 s34, s31, 49152
    s_nop 0
    buffer_load_dwordx4 v3, s[8:11], s34 offen lds
    s_lshl_b32 s31, s29, 17
    s_add_u32 s31, s31, s28
    s_lshl_b32 s32, s20, 11
    s_add_u32 s32, s32, s30
    s_add_u32 s32, s32, 16384
    s_add_u32 s33, s32, 0
    s_mov_b32 m0, s33
    s_add_u32 s34, s31, 0
    s_nop 0
    buffer_load_dwordx4 v4, s[12:15], s34 offen lds
    s_add_u32 s33, s32, 1024
    s_mov_b32 m0, s33
    s_add_u32 s34, s31, 16384
    s_nop 0
    buffer_load_dwordx4 v4, s[12:15], s34 offen lds
    s_add_u32 s29, s29, 1
    s_add_u32 s30, s30, 24576
    s_cmp_ge_u32 s30, 73728
    s_cselect_b32 s30, 0, s30
k3_fin_nodma:
    v_add_u32 v20, s36, v12
    v_add_u32 v21, s36, v13
    v_add_u32 v22, s36, v14
    v_add_u32 v23, s36, v15
    v_add_u32 v24, s36, v16
    ds_read_b128 v[28:31], v20 offset:0
    ds_read_b128 v[32:35], v20 offset:4096
    ds_read_b64_tr_b16 v[36:37], v24 offset:0
    ds_read_b64_tr_b16 v[38:39], v24 offset:512
    ds_read_b128 v[40:43], v21 offset:0
    ds_read_b128 v[44:47], v21 offset:4096
    ds_read_b64_tr_b16 v[48:49], v24 offset:2048
    ds_read_b64_tr_b16 v[50:51], v24 offset:2560
    s_waitcnt lgkmcnt(4)
    v_mfma_f32_32x32x16_bf16 v[64:79], v[36:39], v[28:31], v[64:79]
    v_mfma_f32_32x32x16_bf16 v[80:95], v[36:39], v[32:35], v[80:95]
    ds_read_b128 v[28:31], v22 offset:0
    ds_read_b128 v[32:35], v22 offset:4096
    ds_read_b64_tr_b16 v[36:37], v24 offset:4096
    ds_read_b64_tr_b16 v[38:39], v24 offset:4608
    s_waitcnt lgkmcnt(4)
    v_mfma_f32_32x32x16_bf16 v[64:79], v[48:51], v[40:43], v[64:79]
    v_mfma_f32_32x32x16_bf16 v[80:95], v[48:51], v[44:47], v[80:95]
    ds_read_b128 v[40:43], v23 offset:0
    ds_read_b128 v[44:47], v23 offset:4096
    ds_read_b64_tr_b16 v[48:49], v24 offset:6144
    ds_read_b64_tr_b16 v[50:51], v24 offset:6656
    s_waitcnt lgkmcnt(4)
    v_mfma_f32_32x32x16_bf16 v[64:79], v[36:39], v[28:31], v[64:79]
    v_mfma_f32_32x32x16_bf16 v[80:95], v[36:39], v[32:35], v[80:95]
    s_waitcnt lgkmcnt(0)
    v_mfma_f32_32x32x16_bf16 v[64:79], v[48:51], v[40:43], v[64:79]
    v_mfma_f32_32x32x16_bf16 v[80:95], v[48:51], v[44:47], v[80:95]
    s_add_u32 s36, s36, 24576
    s_cmp_ge_u32 s36, 73728
    s_cselect_b32 s36, 0, s36
    s_add_u32 s35, s35, 1
    s_cmp_lt_u32 s35, 16
    s_cbranch_scc1 k3_fin_loop
    s_lshl_b32 s26, s21, 7
    s_lshl_b32 s27, s23, 6
    s_add_u32 s26, s26, s27
    v_add_u32 v20, s26, v7
    v_lshlrev_b32 v21, 2, v20
    buffer_load_dword v22, v21, s[64:67], 0 offen
    buffer_load_dword v23, v21, s[64:67], 0 offen offset:128
    v_lshlrev_b32 v20, 11, v20
    v_lshl_add_u32 v20, v8, 3, v20
    s_lshl_b32 s26, s22, 7
    s_lshl_b32 s27, s24, 6
    s_add_u32 s26, s26, s27
    v_add_u32 v20, s26, v20
    v_and_b32 v10, 15, v1
    v_lshrrev_b32 v10, 2, v10
    v_lshl_add_u32 v10, v8, 2, v10
    s_lshl_b32 s26, s24, 5
    v_add_u32 v10, s26, v10
    v_lshlrev_b32 v10, 8, v10
    v_add_u32 v10, v10, v18
    s_lshl_b32 s26, s23, 7
    v_add_u32 v10, s26, v10
    v_add_u32 v10, 73728, v10
    ds_read_b64_tr_b16 v[100:101], v10 offset:0
    ds_read_b64_tr_b16 v[102:103], v10 offset:2048
    ds_read_b64_tr_b16 v[104:105], v10 offset:4096
    ds_read_b64_tr_b16 v[106:107], v10 offset:6144
    ds_read_b64_tr_b16 v[108:109], v10 offset:64
    ds_read_b64_tr_b16 v[110:111], v10 offset:2112
    ds_read_b64_tr_b16 v[112:113], v10 offset:4160
    ds_read_b64_tr_b16 v[114:115], v10 offset:6208
    s_waitcnt vmcnt(0) lgkmcnt(0)
    v_sub_f32 v24, 1.0, v22
    v_sub_f32 v25, 1.0, v23
    v_cvt_pk_bf16_f32 v24, v24, v25
    v_lshlrev_b32 v25, 16, v24
    v_and_b32 v26, 0xffff0000, v24
    v_cvt_pk_bf16_f32 v40, v64, v65
    v_cvt_pk_bf16_f32 v41, v66, v67
    v_lshlrev_b32 v42, 16, v40
    v_and_b32 v43, 0xffff0000, v40
    v_lshlrev_b32 v44, 16, v41
    v_and_b32 v45, 0xffff0000, v41
    v_lshlrev_b32 v46, 16, v100
    v_and_b32 v47, 0xffff0000, v100
    v_lshlrev_b32 v48, 16, v101
    v_and_b32 v49, 0xffff0000, v101
    v_mul_f32 v42, v42, v25
    v_mul_f32 v46, v46, v22
    v_mul_f32 v43, v43, v25
    v_mul_f32 v47, v47, v22
    v_mul_f32 v44, v44, v25
    v_mul_f32 v48, v48, v22
    v_mul_f32 v45, v45, v25
    v_mul_f32 v49, v49, v22
    v_cvt_pk_bf16_f32 v40, v42, v43
    v_cvt_pk_bf16_f32 v41, v44, v45
    v_cvt_pk_bf16_f32 v50, v46, v47
    v_cvt_pk_bf16_f32 v51, v48, v49
    v_lshlrev_b32 v42, 16, v40
    v_and_b32 v43, 0xffff0000, v40
    v_lshlrev_b32 v44, 16, v41
    v_and_b32 v45, 0xffff0000, v41
    v_lshlrev_b32 v46, 16, v50
    v_and_b32 v47, 0xffff0000, v50
    v_lshlrev_b32 v48, 16, v51
    v_and_b32 v49, 0xffff0000, v51
    v_add_f32 v42, v42, v46
    v_add_f32 v43, v43, v47
    v_add_f32 v44, v44, v48
    v_add_f32 v45, v45, v49
    v_cvt_pk_bf16_f32 v100, v42, v43
    v_cvt_pk_bf16_f32 v101, v44, v45
    buffer_store_dwordx2 v[100:101], v20, s[16:19], 0 offen offset:0
    v_cvt_pk_bf16_f32 v40, v68, v69
    v_cvt_pk_bf16_f32 v41, v70, v71
    v_lshlrev_b32 v42, 16, v40
    v_and_b32 v43, 0xffff0000, v40
    v_lshlrev_b32 v44, 16, v41
    v_and_b32 v45, 0xffff0000, v41
    v_lshlrev_b32 v46, 16, v102
    v_and_b32 v47, 0xffff0000, v102
    v_lshlrev_b32 v48, 16, v103
    v_and_b32 v49, 0xffff0000, v103
    v_mul_f32 v42, v42, v25
    v_mul_f32 v46, v46, v22
    v_mul_f32 v43, v43, v25
    v_mul_f32 v47, v47, v22
    v_mul_f32 v44, v44, v25
    v_mul_f32 v48, v48, v22
    v_mul_f32 v45, v45, v25
    v_mul_f32 v49, v49, v22
    v_cvt_pk_bf16_f32 v40, v42, v43
    v_cvt_pk_bf16_f32 v41, v44, v45
    v_cvt_pk_bf16_f32 v50, v46, v47
    v_cvt_pk_bf16_f32 v51, v48, v49
    v_lshlrev_b32 v42, 16, v40
    v_and_b32 v43, 0xffff0000, v40
    v_lshlrev_b32 v44, 16, v41
    v_and_b32 v45, 0xffff0000, v41
    v_lshlrev_b32 v46, 16, v50
    v_and_b32 v47, 0xffff0000, v50
    v_lshlrev_b32 v48, 16, v51
    v_and_b32 v49, 0xffff0000, v51
    v_add_f32 v42, v42, v46
    v_add_f32 v43, v43, v47
    v_add_f32 v44, v44, v48
    v_add_f32 v45, v45, v49
    v_cvt_pk_bf16_f32 v102, v42, v43
    v_cvt_pk_bf16_f32 v103, v44, v45
    buffer_store_dwordx2 v[102:103], v20, s[16:19], 0 offen offset:16
    v_cvt_pk_bf16_f32 v40, v72, v73
    v_cvt_pk_bf16_f32 v41, v74, v75
    v_lshlrev_b32 v42, 16, v40
    v_and_b32 v43, 0xffff0000, v40
    v_lshlrev_b32 v44, 16, v41
    v_and_b32 v45, 0xffff0000, v41
    v_lshlrev_b32 v46, 16, v104
    v_and_b32 v47, 0xffff0000, v104
    v_lshlrev_b32 v48, 16, v105
    v_and_b32 v49, 0xffff0000, v105
    v_mul_f32 v42, v42, v25
    v_mul_f32 v46, v46, v22
    v_mul_f32 v43, v43, v25
    v_mul_f32 v47, v47, v22
    v_mul_f32 v44, v44, v25
    v_mul_f32 v48, v48, v22
    v_mul_f32 v45, v45, v25
    v_mul_f32 v49, v49, v22
    v_cvt_pk_bf16_f32 v40, v42, v43
    v_cvt_pk_bf16_f32 v41, v44, v45
    v_cvt_pk_bf16_f32 v50, v46, v47
    v_cvt_pk_bf16_f32 v51, v48, v49
    v_lshlrev_b32 v42, 16, v40
    v_and_b32 v43, 0xffff0000, v40
    v_lshlrev_b32 v44, 16, v41
    v_and_b32 v45, 0xffff0000, v41
    v_lshlrev_b32 v46, 16, v50
    v_and_b32 v47, 0xffff0000, v50
    v_lshlrev_b32 v48, 16, v51
    v_and_b32 v49, 0xffff0000, v51
    v_add_f32 v42, v42, v46
    v_add_f32 v43, v43, v47
    v_add_f32 v44, v44, v48
    v_add_f32 v45, v45, v49
    v_cvt_pk_bf16_f32 v104, v42, v43
    v_cvt_pk_bf16_f32 v105, v44, v45
    buffer_store_dwordx2 v[104:105], v20, s[16:19], 0 offen offset:32
    v_cvt_pk_bf16_f32 v40, v76, v77
    v_cvt_pk_bf16_f32 v41, v78, v79
    v_lshlrev_b32 v42, 16, v40
    v_and_b32 v43, 0xffff0000, v40
    v_lshlrev_b32 v44, 16, v41
    v_and_b32 v45, 0xffff0000, v41
    v_lshlrev_b32 v46, 16, v106
    v_and_b32 v47, 0xffff0000, v106
    v_lshlrev_b32 v48, 16, v107
    v_and_b32 v49, 0xffff0000, v107
    v_mul_f32 v42, v42, v25
    v_mul_f32 v46, v46, v22
    v_mul_f32 v43, v43, v25
    v_mul_f32 v47, v47, v22
    v_mul_f32 v44, v44, v25
    v_mul_f32 v48, v48, v22
    v_mul_f32 v45, v45, v25
    v_mul_f32 v49, v49, v22
    v_cvt_pk_bf16_f32 v40, v42, v43
    v_cvt_pk_bf16_f32 v41, v44, v45
    v_cvt_pk_bf16_f32 v50, v46, v47
    v_cvt_pk_bf16_f32 v51, v48, v49
    v_lshlrev_b32 v42, 16, v40
    v_and_b32 v43, 0xffff0000, v40
    v_lshlrev_b32 v44, 16, v41
    v_and_b32 v45, 0xffff0000, v41
    v_lshlrev_b32 v46, 16, v50
    v_and_b32 v47, 0xffff0000, v50
    v_lshlrev_b32 v48, 16, v51
    v_and_b32 v49, 0xffff0000, v51
    v_add_f32 v42, v42, v46
    v_add_f32 v43, v43, v47
    v_add_f32 v44, v44, v48
    v_add_f32 v45, v45, v49
    v_cvt_pk_bf16_f32 v106, v42, v43
    v_cvt_pk_bf16_f32 v107, v44, v45
    buffer_store_dwordx2 v[106:107], v20, s[16:19], 0 offen offset:48
    v_cvt_pk_bf16_f32 v40, v80, v81
    v_cvt_pk_bf16_f32 v41, v82, v83
    v_lshlrev_b32 v42, 16, v40
    v_and_b32 v43, 0xffff0000, v40
    v_lshlrev_b32 v44, 16, v41
    v_and_b32 v45, 0xffff0000, v41
    v_lshlrev_b32 v46, 16, v108
    v_and_b32 v47, 0xffff0000, v108
    v_lshlrev_b32 v48, 16, v109
    v_and_b32 v49, 0xffff0000, v109
    v_mul_f32 v42, v42, v26
    v_mul_f32 v46, v46, v23
    v_mul_f32 v43, v43, v26
    v_mul_f32 v47, v47, v23
    v_mul_f32 v44, v44, v26
    v_mul_f32 v48, v48, v23
    v_mul_f32 v45, v45, v26
    v_mul_f32 v49, v49, v23
    v_cvt_pk_bf16_f32 v40, v42, v43
    v_cvt_pk_bf16_f32 v41, v44, v45
    v_cvt_pk_bf16_f32 v50, v46, v47
    v_cvt_pk_bf16_f32 v51, v48, v49
    v_lshlrev_b32 v42, 16, v40
    v_and_b32 v43, 0xffff0000, v40
    v_lshlrev_b32 v44, 16, v41
    v_and_b32 v45, 0xffff0000, v41
    v_lshlrev_b32 v46, 16, v50
    v_and_b32 v47, 0xffff0000, v50
    v_lshlrev_b32 v48, 16, v51
    v_and_b32 v49, 0xffff0000, v51
    v_add_f32 v42, v42, v46
    v_add_f32 v43, v43, v47
    v_add_f32 v44, v44, v48
    v_add_f32 v45, v45, v49
    v_cvt_pk_bf16_f32 v108, v42, v43
    v_cvt_pk_bf16_f32 v109, v44, v45
    s_mov_b32 s27, 65536
    buffer_store_dwordx2 v[108:109], v20, s[16:19], s27 offen offset:0
    v_cvt_pk_bf16_f32 v40, v84, v85
    v_cvt_pk_bf16_f32 v41, v86, v87
    v_lshlrev_b32 v42, 16, v40
    v_and_b32 v43, 0xffff0000, v40
    v_lshlrev_b32 v44, 16, v41
    v_and_b32 v45, 0xffff0000, v41
    v_lshlrev_b32 v46, 16, v110
    v_and_b32 v47, 0xffff0000, v110
    v_lshlrev_b32 v48, 16, v111
    v_and_b32 v49, 0xffff0000, v111
    v_mul_f32 v42, v42, v26
    v_mul_f32 v46, v46, v23
    v_mul_f32 v43, v43, v26
    v_mul_f32 v47, v47, v23
    v_mul_f32 v44, v44, v26
    v_mul_f32 v48, v48, v23
    v_mul_f32 v45, v45, v26
    v_mul_f32 v49, v49, v23
    v_cvt_pk_bf16_f32 v40, v42, v43
    v_cvt_pk_bf16_f32 v41, v44, v45
    v_cvt_pk_bf16_f32 v50, v46, v47
    v_cvt_pk_bf16_f32 v51, v48, v49
    v_lshlrev_b32 v42, 16, v40
    v_and_b32 v43, 0xffff0000, v40
    v_lshlrev_b32 v44, 16, v41
    v_and_b32 v45, 0xffff0000, v41
    v_lshlrev_b32 v46, 16, v50
    v_and_b32 v47, 0xffff0000, v50
    v_lshlrev_b32 v48, 16, v51
    v_and_b32 v49, 0xffff0000, v51
    v_add_f32 v42, v42, v46
    v_add_f32 v43, v43, v47
    v_add_f32 v44, v44, v48
    v_add_f32 v45, v45, v49
    v_cvt_pk_bf16_f32 v110, v42, v43
    v_cvt_pk_bf16_f32 v111, v44, v45
    s_mov_b32 s27, 65536
    buffer_store_dwordx2 v[110:111], v20, s[16:19], s27 offen offset:16
    v_cvt_pk_bf16_f32 v40, v88, v89
    v_cvt_pk_bf16_f32 v41, v90, v91
    v_lshlrev_b32 v42, 16, v40
    v_and_b32 v43, 0xffff0000, v40
    v_lshlrev_b32 v44, 16, v41
    v_and_b32 v45, 0xffff0000, v41
    v_lshlrev_b32 v46, 16, v112
    v_and_b32 v47, 0xffff0000, v112
    v_lshlrev_b32 v48, 16, v113
    v_and_b32 v49, 0xffff0000, v113
    v_mul_f32 v42, v42, v26
    v_mul_f32 v46, v46, v23
    v_mul_f32 v43, v43, v26
    v_mul_f32 v47, v47, v23
    v_mul_f32 v44, v44, v26
    v_mul_f32 v48, v48, v23
    v_mul_f32 v45, v45, v26
    v_mul_f32 v49, v49, v23
    v_cvt_pk_bf16_f32 v40, v42, v43
    v_cvt_pk_bf16_f32 v41, v44, v45
    v_cvt_pk_bf16_f32 v50, v46, v47
    v_cvt_pk_bf16_f32 v51, v48, v49
    v_lshlrev_b32 v42, 16, v40
    v_and_b32 v43, 0xffff0000, v40
    v_lshlrev_b32 v44, 16, v41
    v_and_b32 v45, 0xffff0000, v41
    v_lshlrev_b32 v46, 16, v50
    v_and_b32 v47, 0xffff0000, v50
    v_lshlrev_b32 v48, 16, v51
    v_and_b32 v49, 0xffff0000, v51
    v_add_f32 v42, v42, v46
    v_add_f32 v43, v43, v47
    v_add_f32 v44, v44, v48
    v_add_f32 v45, v45, v49
    v_cvt_pk_bf16_f32 v112, v42, v43
    v_cvt_pk_bf16_f32 v113, v44, v45
    s_mov_b32 s27, 65536
    buffer_store_dwordx2 v[112:113], v20, s[16:19], s27 offen offset:32
    v_cvt_pk_bf16_f32 v40, v92, v93
    v_cvt_pk_bf16_f32 v41, v94, v95
    v_lshlrev_b32 v42, 16, v40
    v_and_b32 v43, 0xffff0000, v40
    v_lshlrev_b32 v44, 16, v41
    v_and_b32 v45, 0xffff0000, v41
    v_lshlrev_b32 v46, 16, v114
    v_and_b32 v47, 0xffff0000, v114
    v_lshlrev_b32 v48, 16, v115
    v_and_b32 v49, 0xffff0000, v115
    v_mul_f32 v42, v42, v26
    v_mul_f32 v46, v46, v23
    v_mul_f32 v43, v43, v26
    v_mul_f32 v47, v47, v23
    v_mul_f32 v44, v44, v26
    v_mul_f32 v48, v48, v23
    v_mul_f32 v45, v45, v26
    v_mul_f32 v49, v49, v23
    v_cvt_pk_bf16_f32 v40, v42, v43
    v_cvt_pk_bf16_f32 v41, v44, v45
    v_cvt_pk_bf16_f32 v50, v46, v47
    v_cvt_pk_bf16_f32 v51, v48, v49
    v_lshlrev_b32 v42, 16, v40
    v_and_b32 v43, 0xffff0000, v40
    v_lshlrev_b32 v44, 16, v41
    v_and_b32 v45, 0xffff0000, v41
    v_lshlrev_b32 v46, 16, v50
    v_and_b32 v47, 0xffff0000, v50
    v_lshlrev_b32 v48, 16, v51
    v_and_b32 v49, 0xffff0000, v51
    v_add_f32 v42, v42, v46
    v_add_f32 v43, v43, v47
    v_add_f32 v44, v44, v48
    v_add_f32 v45, v45, v49
    v_cvt_pk_bf16_f32 v114, v42, v43
    v_cvt_pk_bf16_f32 v115, v44, v45
    s_mov_b32 s27, 65536
    buffer_store_dwordx2 v[114:115], v20, s[16:19], s27 offen offset:48
    s_endpgm
.section .rodata,"a"
.p2align 6
.amdhsa_kernel k1_kernel
  .amdhsa_next_free_vgpr 160
  .amdhsa_next_free_sgpr 102
  .amdhsa_accum_offset 160
  .amdhsa_group_segment_fixed_size 0
  .amdhsa_kernarg_size 128
  .amdhsa_user_sgpr_count 2
  .amdhsa_user_sgpr_kernarg_segment_ptr 1
  .amdhsa_system_sgpr_workgroup_id_x 1
.end_amdhsa_kernel
.section .rodata,"a"
.p2align 6
.amdhsa_kernel k2_kernel
  .amdhsa_next_free_vgpr 256
  .amdhsa_next_free_sgpr 102
  .amdhsa_accum_offset 256
  .amdhsa_group_segment_fixed_size 0
  .amdhsa_kernarg_size 128
  .amdhsa_user_sgpr_count 2
  .amdhsa_user_sgpr_kernarg_segment_ptr 1
  .amdhsa_system_sgpr_workgroup_id_x 1
.end_amdhsa_kernel
.section .rodata,"a"
.p2align 6
.amdhsa_kernel k3_kernel
  .amdhsa_next_free_vgpr 128
  .amdhsa_next_free_sgpr 102
  .amdhsa_accum_offset 128
  .amdhsa_group_segment_fixed_size 0
  .amdhsa_kernarg_size 128
  .amdhsa_user_sgpr_count 2
  .amdhsa_user_sgpr_kernarg_segment_ptr 1
  .amdhsa_system_sgpr_workgroup_id_x 1
.end_amdhsa_kernel
```
